```python
import torch

def _softmax(x, axis=-1):
    return torch.softmax(x, dim=axis)
def _gelu(x):
    return torch.nn.functional.gelu(x, approximate="tanh")
def _silu(x):
    return torch.nn.functional.silu(x)
def _sigmoid(x):
    return torch.sigmoid(x)
def _layernorm(x, axis=-1, eps=1e-5):
    m = x.mean(dim=axis, keepdim=True)
    v = x.var(dim=axis, keepdim=True, unbiased=False)
    return (x - m) / torch.sqrt(v + eps)
def _scatter_add(tgt, idx, src, axis=0):
    return tgt.clone().index_add_(axis, idx, src)
def _segment_sum(src, seg, n):
    out = torch.zeros((n,) + src.shape[1:], dtype=src.dtype)
    return out.index_add_(0, seg, src)
def _pad(x, pw):
    flat = tuple(v for pair in reversed(pw) for v in pair)
    return torch.nn.functional.pad(x, flat)

kernel_name = 'recurrent_scan__linear_attn_block__glu_gated_swiglu__prompt'

def setup_inputs():

    _w = (lambda a: (lambda t: t.to(torch.bfloat16) if t.is_floating_point() else t)(torch.as_tensor(a)))
    def _A_setup():
        B, S, D = 1, 2048, 448
        return {
            "x": _w((lambda *s: torch.randn(*s, dtype=torch.bfloat16) * 0.05)(B, S, D)),
            "wqkv": _w((lambda *s: torch.randn(*s, dtype=torch.bfloat16) * 0.8)(D, 3 * D)),
            "wo": _w((lambda *s: torch.randn(*s, dtype=torch.bfloat16) * 0.8)(D, D)),
        }
    _A_in = _A_setup()

    def _B_setup():
        B, S, D, F = 1, 2048, 448, 1792
        return {
            "x": _w((lambda *s: torch.randn(*s, dtype=torch.bfloat16) * 0.05)(B, S, D)),
            "w1": _w((lambda *s: torch.randn(*s, dtype=torch.bfloat16) * 0.2)(D, F) * (2.0 / D) ** 0.5),
            "w3": _w((lambda *s: torch.randn(*s, dtype=torch.bfloat16) * 0.2)(D, F) * (2.0 / D) ** 0.5),
            "w2": _w((lambda *s: torch.randn(*s, dtype=torch.bfloat16) * 0.2)(F, D) * (2.0 / F) ** 0.5),
        }
    _B_in = _B_setup()

    return {
        "A_x": _A_in["x"],
        "A_wqkv": _A_in["wqkv"],
        "A_wo": _A_in["wo"],
        "B_x": _B_in["x"],
        "B_w1": _B_in["w1"],
        "B_w3": _B_in["w3"],
        "B_w2": _B_in["w2"],
    }

def reference(A_x, A_wqkv, A_wo, B_x, B_w1, B_w3, B_w2):
    def _A_ref(x, wqkv, wo):
        B, S, D = x.shape
        H = 16; Dh = D // H
        qkv = (lambda x, *d: x.permute(*d))((x @ wqkv).reshape(B, S, 3, H, Dh), 2, 0, 3, 1, 4)
        q, k, v = qkv[0], qkv[1], qkv[2]
        phi = lambda t: torch.where(t > 0, t + 1, torch.exp(t)) + 1e-6
        pq, pk = phi(q), phi(k)
        kv = torch.einsum("bhsd,bhse->bhde", pk, v)
        z = torch.einsum("bhsd->bhd", pk)
        num = torch.einsum("bhqd,bhde->bhqe", pq, kv)
        den = torch.einsum("bhqd,bhd->bhq", pq, z)[..., None] + 1e-6
        o = num / den
        return (lambda x, *d: x.permute(*d))(o, 0, 2, 1, 3).reshape(B, S, D) @ wo

    def _B_ref(x, w1, w3, w2):
        gate = torch.einsum("bsd,df->bsf", x, w1)
        up = torch.einsum("bsd,df->bsf", x, w3)
        h = _silu(gate) * up
        out = torch.einsum("bsf,fd->bsd", h, w2)
        return out

    x = A_x
    xn = _layernorm(x, axis=-1)
    s = _A_ref(xn, A_wqkv, A_wo)
    g = _silu(_B_ref(xn, B_w1, B_w3, B_w2))
    return x + s * g
```

```asm
; @launch kernel=k1_kernel grid=(256,1,1) block=(512,1,1) lds=163840
; @launch kernel=k23_kernel grid=(256,1,1) block=(512,1,1) lds=149504
.amdgcn_target "amdgcn-amd-amdhsa--gfx950"
.text
.globl k1_kernel
.p2align 8
.type k1_kernel,@function
k1_kernel:
    s_cmp_ge_u32 s2, 256
    s_cbranch_scc1 k1_done
    v_lshrrev_b32 v1, 6, v0
    s_nop 0
    v_readfirstlane_b32 s53, v1
    s_nop 3
    s_add_u32 s53, s53, s2
    s_load_dwordx4 s[4:7], s[0:1], 0
    s_load_dwordx4 s[8:11], s[0:1], 32
    s_load_dwordx2 s[12:13], s[0:1], 72
    s_lshr_b32 s3, s2, 4
    s_and_b32 s2, s2, 15
    v_lshrrev_b32 v1, 6, v0
    s_nop 0
    v_readfirstlane_b32 s14, v1
    v_and_b32 v1, 63, v0
    s_waitcnt lgkmcnt(0)
    s_mov_b32 s16, s4
    s_mov_b32 s17, s5
    s_mov_b32 s18, 1835008
    s_mov_b32 s19, 0x00020000
    s_mov_b32 s20, s6
    s_mov_b32 s21, s7
    s_mov_b32 s22, 1204224
    s_mov_b32 s23, 0x00020000
    s_mov_b32 s24, s8
    s_mov_b32 s25, s9
    s_mov_b32 s26, 1605632
    s_mov_b32 s27, 0x00020000
    s_mov_b32 s28, s10
    s_mov_b32 s29, s11
    s_mov_b32 s30, 1605632
    s_mov_b32 s31, 0x00020000
    s_mov_b32 s32, s12
    s_mov_b32 s33, s13
    s_mov_b32 s34, 268435456
    s_mov_b32 s35, 0x00020000
    v_mov_b32 v4, 0
    v_mov_b32 v5, 0
    s_mov_b32 s36, 0x2ab
    v_mul_lo_u32 v6, v0, s36
    v_lshrrev_b32 v6, 16, v6
    v_mul_u32_u24 v7, 96, v6
    v_sub_u32 v7, v0, v7
    s_mov_b32 s36, 0x5556
    v_mul_lo_u32 v8, v7, s36
    v_lshrrev_b32 v8, 16, v8
    v_mul_u32_u24 v9, 3, v8
    v_sub_u32 v9, v7, v9
    v_mul_u32_u24 v10, 704, v8
    v_and_b32 v11, 8, v8
    v_lshlrev_b32 v11, 2, v11
    v_add_u32 v10, v10, v11
    v_lshlrev_b32 v11, 6, v9
    v_add_u32 v10, v10, v11
    v_mul_u32_u24 v11, 22528, v6
    v_add_u32 v10, v10, v11
    v_add_u32 v10, 118840, v10
    v_cmp_gt_u32 vcc, 192, v0
    s_and_saveexec_b64 s[38:39], vcc
    s_cbranch_execz k1_nz
    ds_write_b64 v10, v[4:5]
k1_nz:
    s_mov_b64 exec, s[38:39]
    s_mov_b32 s36, 4682
    v_mul_lo_u32 v6, v0, s36
    v_lshrrev_b32 v6, 16, v6
    v_mul_u32_u24 v7, 14, v6
    v_sub_u32 v7, v0, v7
    v_mul_u32_u24 v2, 3584, v6
    v_lshlrev_b32 v8, 4, v7
    v_add_u32 v2, v2, v8
    s_mul_i32 s36, s2, 224
    v_add_u32 v2, s36, v2
    v_mul_u32_u24 v3, 704, v6
    v_and_b32 v9, 8, v6
    v_lshlrev_b32 v9, 2, v9
    v_add_u32 v3, v3, v9
    v_add_u32 v3, v3, v8
    v_add_u32 v3, 118976, v3
    s_mov_b32 s36, 3121
    v_mul_lo_u32 v6, v0, s36
    v_lshrrev_b32 v6, 16, v6
    v_mul_u32_u24 v7, 21, v6
    v_sub_u32 v7, v0, v7
    s_mov_b32 s36, 9363
    v_mul_lo_u32 v8, v7, s36
    v_lshrrev_b32 v8, 16, v8
    v_mul_u32_u24 v9, 7, v8
    v_sub_u32 v9, v7, v9
    v_mul_u32_u24 v12, 2688, v6
    v_mul_u32_u24 v10, 896, v8
    v_add_u32 v12, v12, v10
    v_lshlrev_b32 v10, 3, v9
    v_add_u32 v12, v12, v10
    s_mul_i32 s36, s2, 56
    v_add_u32 v12, s36, v12
    v_mul_u32_u24 v13, 704, v6
    v_and_b32 v11, 8, v6
    v_lshlrev_b32 v11, 2, v11
    v_add_u32 v13, v13, v11
    v_add_u32 v13, v13, v10
    v_lshlrev_b32 v11, 6, v8
    v_add_u32 v13, v13, v11
    v_add_u32 v13, 118784, v13
    v_sub_u32 v14, 1023, v0
    s_mov_b32 s36, 3121
    v_mul_lo_u32 v6, v14, s36
    v_lshrrev_b32 v6, 16, v6
    v_mul_u32_u24 v7, 21, v6
    v_sub_u32 v7, v14, v7
    s_mov_b32 s36, 9363
    v_mul_lo_u32 v8, v7, s36
    v_lshrrev_b32 v8, 16, v8
    v_mul_u32_u24 v9, 7, v8
    v_sub_u32 v9, v7, v9
    v_mul_u32_u24 v14, 2688, v6
    v_mul_u32_u24 v10, 896, v8
    v_add_u32 v14, v14, v10
    v_lshlrev_b32 v10, 3, v9
    v_add_u32 v14, v14, v10
    s_mul_i32 s36, s2, 56
    v_add_u32 v14, s36, v14
    v_mul_u32_u24 v15, 704, v6
    v_and_b32 v11, 8, v6
    v_lshlrev_b32 v11, 2, v11
    v_add_u32 v15, v15, v11
    v_add_u32 v15, v15, v10
    v_lshlrev_b32 v11, 6, v8
    v_add_u32 v15, v15, v11
    v_add_u32 v15, 118784, v15
    v_cmp_gt_u32 vcc, 448, v0
    s_mov_b64 s[40:41], vcc
    v_cmp_lt_u32 vcc, 351, v0
    s_mov_b64 s[42:43], vcc
    s_mov_b32 s44, 0
    s_mov_b32 s45, 0
    s_mov_b64 exec, s[40:41]
    buffer_load_dwordx4 v[16:19], v2, s[24:27], s44 offen
    buffer_load_dwordx4 v[20:23], v2, s[28:31], s44 offen
    s_mov_b64 exec, s[42:43]
    buffer_load_dwordx2 v[26:27], v14, s[20:23], s45 offen
    s_mov_b64 exec, -1
    buffer_load_dwordx2 v[24:25], v12, s[20:23], s45 offen
    s_add_u32 s44, s44, 114688
    s_add_u32 s45, s45, 86016
    s_mov_b64 exec, s[40:41]
    buffer_load_dwordx4 v[180:183], v2, s[24:27], s44 offen
    buffer_load_dwordx4 v[184:187], v2, s[28:31], s44 offen
    s_mov_b64 exec, s[42:43]
    buffer_load_dwordx2 v[190:191], v14, s[20:23], s45 offen
    s_mov_b64 exec, -1
    buffer_load_dwordx2 v[188:189], v12, s[20:23], s45 offen
    s_lshl_b32 s46, s3, 7
    s_lshl_b32 s47, s14, 4
    s_add_u32 s46, s46, s47
    v_lshrrev_b32 v6, 3, v1
    v_add_u32 v7, s46, v6
    v_mul_u32_u24 v7, 896, v7
    v_and_b32 v8, 7, v1
    v_lshlrev_b32 v8, 4, v8
    v_add_u32 v7, v7, v8
    buffer_load_dwordx4 v[32:35], v7, s[16:19], 0 offen offset:0
    buffer_load_dwordx4 v[36:39], v7, s[16:19], 0 offen offset:128
    buffer_load_dwordx4 v[40:43], v7, s[16:19], 0 offen offset:256
    buffer_load_dwordx4 v[44:47], v7, s[16:19], 0 offen offset:384
    buffer_load_dwordx4 v[48:51], v7, s[16:19], 0 offen offset:512
    buffer_load_dwordx4 v[52:55], v7, s[16:19], 0 offen offset:640
    buffer_load_dwordx4 v[56:59], v7, s[16:19], 0 offen offset:768
    v_add_u32 v7, 7168, v7
    buffer_load_dwordx4 v[60:63], v7, s[16:19], 0 offen offset:0
    buffer_load_dwordx4 v[64:67], v7, s[16:19], 0 offen offset:128
    buffer_load_dwordx4 v[68:71], v7, s[16:19], 0 offen offset:256
    buffer_load_dwordx4 v[72:75], v7, s[16:19], 0 offen offset:384
    buffer_load_dwordx4 v[76:79], v7, s[16:19], 0 offen offset:512
    buffer_load_dwordx4 v[80:83], v7, s[16:19], 0 offen offset:640
    buffer_load_dwordx4 v[84:87], v7, s[16:19], 0 offen offset:768
    v_add_u32 v9, s47, v6
    v_mul_u32_u24 v9, 928, v9
    v_add_u32 v9, v9, v8
    s_mov_b32 s48, 0x3f803f80
    s_waitcnt vmcnt(7)
    v_mov_b32 v10, 0
    v_mov_b32 v11, 0
    v_dot2_f32_bf16 v10, v32, s48, v10
    v_dot2_f32_bf16 v11, v32, v32, v11
    v_dot2_f32_bf16 v10, v33, s48, v10
    v_dot2_f32_bf16 v11, v33, v33, v11
    v_dot2_f32_bf16 v10, v34, s48, v10
    v_dot2_f32_bf16 v11, v34, v34, v11
    v_dot2_f32_bf16 v10, v35, s48, v10
    v_dot2_f32_bf16 v11, v35, v35, v11
    v_dot2_f32_bf16 v10, v36, s48, v10
    v_dot2_f32_bf16 v11, v36, v36, v11
    v_dot2_f32_bf16 v10, v37, s48, v10
    v_dot2_f32_bf16 v11, v37, v37, v11
    v_dot2_f32_bf16 v10, v38, s48, v10
    v_dot2_f32_bf16 v11, v38, v38, v11
    v_dot2_f32_bf16 v10, v39, s48, v10
    v_dot2_f32_bf16 v11, v39, v39, v11
    v_dot2_f32_bf16 v10, v40, s48, v10
    v_dot2_f32_bf16 v11, v40, v40, v11
    v_dot2_f32_bf16 v10, v41, s48, v10
    v_dot2_f32_bf16 v11, v41, v41, v11
    v_dot2_f32_bf16 v10, v42, s48, v10
    v_dot2_f32_bf16 v11, v42, v42, v11
    v_dot2_f32_bf16 v10, v43, s48, v10
    v_dot2_f32_bf16 v11, v43, v43, v11
    v_dot2_f32_bf16 v10, v44, s48, v10
    v_dot2_f32_bf16 v11, v44, v44, v11
    v_dot2_f32_bf16 v10, v45, s48, v10
    v_dot2_f32_bf16 v11, v45, v45, v11
    v_dot2_f32_bf16 v10, v46, s48, v10
    v_dot2_f32_bf16 v11, v46, v46, v11
    v_dot2_f32_bf16 v10, v47, s48, v10
    v_dot2_f32_bf16 v11, v47, v47, v11
    v_dot2_f32_bf16 v10, v48, s48, v10
    v_dot2_f32_bf16 v11, v48, v48, v11
    v_dot2_f32_bf16 v10, v49, s48, v10
    v_dot2_f32_bf16 v11, v49, v49, v11
    v_dot2_f32_bf16 v10, v50, s48, v10
    v_dot2_f32_bf16 v11, v50, v50, v11
    v_dot2_f32_bf16 v10, v51, s48, v10
    v_dot2_f32_bf16 v11, v51, v51, v11
    v_dot2_f32_bf16 v10, v52, s48, v10
    v_dot2_f32_bf16 v11, v52, v52, v11
    v_dot2_f32_bf16 v10, v53, s48, v10
    v_dot2_f32_bf16 v11, v53, v53, v11
    v_dot2_f32_bf16 v10, v54, s48, v10
    v_dot2_f32_bf16 v11, v54, v54, v11
    v_dot2_f32_bf16 v10, v55, s48, v10
    v_dot2_f32_bf16 v11, v55, v55, v11
    v_dot2_f32_bf16 v10, v56, s48, v10
    v_dot2_f32_bf16 v11, v56, v56, v11
    v_dot2_f32_bf16 v10, v57, s48, v10
    v_dot2_f32_bf16 v11, v57, v57, v11
    v_dot2_f32_bf16 v10, v58, s48, v10
    v_dot2_f32_bf16 v11, v58, v58, v11
    v_dot2_f32_bf16 v10, v59, s48, v10
    v_dot2_f32_bf16 v11, v59, v59, v11
    ds_swizzle_b32 v88, v10 offset:1055
    ds_swizzle_b32 v89, v11 offset:1055
    s_waitcnt lgkmcnt(0)
    v_add_f32 v10, v10, v88
    v_add_f32 v11, v11, v89
    ds_swizzle_b32 v88, v10 offset:2079
    ds_swizzle_b32 v89, v11 offset:2079
    s_waitcnt lgkmcnt(0)
    v_add_f32 v10, v10, v88
    v_add_f32 v11, v11, v89
    ds_swizzle_b32 v88, v10 offset:4127
    ds_swizzle_b32 v89, v11 offset:4127
    s_waitcnt lgkmcnt(0)
    v_add_f32 v10, v10, v88
    v_add_f32 v11, v11, v89
    v_mul_f32 v10, 0x3b124925, v10
    v_mul_f32 v11, 0x3b124925, v11
    v_fma_f32 v11, -v10, v10, v11
    v_max_f32 v11, 0, v11
    v_add_f32 v11, 0x3727c5ac, v11
    v_rsq_f32 v11, v11
    s_nop 0
    v_mul_f32 v10, v10, v11
    v_sub_f32 v10, 0, v10
    v_lshlrev_b32 v88, 16, v32
    v_and_b32 v89, 0xffff0000, v32
    v_fma_f32 v88, v88, v11, v10
    v_fma_f32 v89, v89, v11, v10
    v_cvt_pk_bf16_f32 v32, v88, v89
    v_lshlrev_b32 v88, 16, v33
    v_and_b32 v89, 0xffff0000, v33
    v_fma_f32 v88, v88, v11, v10
    v_fma_f32 v89, v89, v11, v10
    v_cvt_pk_bf16_f32 v33, v88, v89
    v_lshlrev_b32 v88, 16, v34
    v_and_b32 v89, 0xffff0000, v34
    v_fma_f32 v88, v88, v11, v10
    v_fma_f32 v89, v89, v11, v10
    v_cvt_pk_bf16_f32 v34, v88, v89
    v_lshlrev_b32 v88, 16, v35
    v_and_b32 v89, 0xffff0000, v35
    v_fma_f32 v88, v88, v11, v10
    v_fma_f32 v89, v89, v11, v10
    v_cvt_pk_bf16_f32 v35, v88, v89
    v_lshlrev_b32 v88, 16, v36
    v_and_b32 v89, 0xffff0000, v36
    v_fma_f32 v88, v88, v11, v10
    v_fma_f32 v89, v89, v11, v10
    v_cvt_pk_bf16_f32 v36, v88, v89
    v_lshlrev_b32 v88, 16, v37
    v_and_b32 v89, 0xffff0000, v37
    v_fma_f32 v88, v88, v11, v10
    v_fma_f32 v89, v89, v11, v10
    v_cvt_pk_bf16_f32 v37, v88, v89
    v_lshlrev_b32 v88, 16, v38
    v_and_b32 v89, 0xffff0000, v38
    v_fma_f32 v88, v88, v11, v10
    v_fma_f32 v89, v89, v11, v10
    v_cvt_pk_bf16_f32 v38, v88, v89
    v_lshlrev_b32 v88, 16, v39
    v_and_b32 v89, 0xffff0000, v39
    v_fma_f32 v88, v88, v11, v10
    v_fma_f32 v89, v89, v11, v10
    v_cvt_pk_bf16_f32 v39, v88, v89
    v_lshlrev_b32 v88, 16, v40
    v_and_b32 v89, 0xffff0000, v40
    v_fma_f32 v88, v88, v11, v10
    v_fma_f32 v89, v89, v11, v10
    v_cvt_pk_bf16_f32 v40, v88, v89
    v_lshlrev_b32 v88, 16, v41
    v_and_b32 v89, 0xffff0000, v41
    v_fma_f32 v88, v88, v11, v10
    v_fma_f32 v89, v89, v11, v10
    v_cvt_pk_bf16_f32 v41, v88, v89
    v_lshlrev_b32 v88, 16, v42
    v_and_b32 v89, 0xffff0000, v42
    v_fma_f32 v88, v88, v11, v10
    v_fma_f32 v89, v89, v11, v10
    v_cvt_pk_bf16_f32 v42, v88, v89
    v_lshlrev_b32 v88, 16, v43
    v_and_b32 v89, 0xffff0000, v43
    v_fma_f32 v88, v88, v11, v10
    v_fma_f32 v89, v89, v11, v10
    v_cvt_pk_bf16_f32 v43, v88, v89
    v_lshlrev_b32 v88, 16, v44
    v_and_b32 v89, 0xffff0000, v44
    v_fma_f32 v88, v88, v11, v10
    v_fma_f32 v89, v89, v11, v10
    v_cvt_pk_bf16_f32 v44, v88, v89
    v_lshlrev_b32 v88, 16, v45
    v_and_b32 v89, 0xffff0000, v45
    v_fma_f32 v88, v88, v11, v10
    v_fma_f32 v89, v89, v11, v10
    v_cvt_pk_bf16_f32 v45, v88, v89
    v_lshlrev_b32 v88, 16, v46
    v_and_b32 v89, 0xffff0000, v46
    v_fma_f32 v88, v88, v11, v10
    v_fma_f32 v89, v89, v11, v10
    v_cvt_pk_bf16_f32 v46, v88, v89
    v_lshlrev_b32 v88, 16, v47
    v_and_b32 v89, 0xffff0000, v47
    v_fma_f32 v88, v88, v11, v10
    v_fma_f32 v89, v89, v11, v10
    v_cvt_pk_bf16_f32 v47, v88, v89
    v_lshlrev_b32 v88, 16, v48
    v_and_b32 v89, 0xffff0000, v48
    v_fma_f32 v88, v88, v11, v10
    v_fma_f32 v89, v89, v11, v10
    v_cvt_pk_bf16_f32 v48, v88, v89
    v_lshlrev_b32 v88, 16, v49
    v_and_b32 v89, 0xffff0000, v49
    v_fma_f32 v88, v88, v11, v10
    v_fma_f32 v89, v89, v11, v10
    v_cvt_pk_bf16_f32 v49, v88, v89
    v_lshlrev_b32 v88, 16, v50
    v_and_b32 v89, 0xffff0000, v50
    v_fma_f32 v88, v88, v11, v10
    v_fma_f32 v89, v89, v11, v10
    v_cvt_pk_bf16_f32 v50, v88, v89
    v_lshlrev_b32 v88, 16, v51
    v_and_b32 v89, 0xffff0000, v51
    v_fma_f32 v88, v88, v11, v10
    v_fma_f32 v89, v89, v11, v10
    v_cvt_pk_bf16_f32 v51, v88, v89
    v_lshlrev_b32 v88, 16, v52
    v_and_b32 v89, 0xffff0000, v52
    v_fma_f32 v88, v88, v11, v10
    v_fma_f32 v89, v89, v11, v10
    v_cvt_pk_bf16_f32 v52, v88, v89
    v_lshlrev_b32 v88, 16, v53
    v_and_b32 v89, 0xffff0000, v53
    v_fma_f32 v88, v88, v11, v10
    v_fma_f32 v89, v89, v11, v10
    v_cvt_pk_bf16_f32 v53, v88, v89
    v_lshlrev_b32 v88, 16, v54
    v_and_b32 v89, 0xffff0000, v54
    v_fma_f32 v88, v88, v11, v10
    v_fma_f32 v89, v89, v11, v10
    v_cvt_pk_bf16_f32 v54, v88, v89
    v_lshlrev_b32 v88, 16, v55
    v_and_b32 v89, 0xffff0000, v55
    v_fma_f32 v88, v88, v11, v10
    v_fma_f32 v89, v89, v11, v10
    v_cvt_pk_bf16_f32 v55, v88, v89
    v_lshlrev_b32 v88, 16, v56
    v_and_b32 v89, 0xffff0000, v56
    v_fma_f32 v88, v88, v11, v10
    v_fma_f32 v89, v89, v11, v10
    v_cvt_pk_bf16_f32 v56, v88, v89
    v_lshlrev_b32 v88, 16, v57
    v_and_b32 v89, 0xffff0000, v57
    v_fma_f32 v88, v88, v11, v10
    v_fma_f32 v89, v89, v11, v10
    v_cvt_pk_bf16_f32 v57, v88, v89
    v_lshlrev_b32 v88, 16, v58
    v_and_b32 v89, 0xffff0000, v58
    v_fma_f32 v88, v88, v11, v10
    v_fma_f32 v89, v89, v11, v10
    v_cvt_pk_bf16_f32 v58, v88, v89
    v_lshlrev_b32 v88, 16, v59
    v_and_b32 v89, 0xffff0000, v59
    v_fma_f32 v88, v88, v11, v10
    v_fma_f32 v89, v89, v11, v10
    v_cvt_pk_bf16_f32 v59, v88, v89
    ds_write_b128 v9, v[32:35] offset:0
    ds_write_b128 v9, v[36:39] offset:128
    ds_write_b128 v9, v[40:43] offset:256
    ds_write_b128 v9, v[44:47] offset:384
    ds_write_b128 v9, v[48:51] offset:512
    ds_write_b128 v9, v[52:55] offset:640
    ds_write_b128 v9, v[56:59] offset:768
    s_waitcnt vmcnt(0)
    v_mov_b32 v10, 0
    v_mov_b32 v11, 0
    v_dot2_f32_bf16 v10, v60, s48, v10
    v_dot2_f32_bf16 v11, v60, v60, v11
    v_dot2_f32_bf16 v10, v61, s48, v10
    v_dot2_f32_bf16 v11, v61, v61, v11
    v_dot2_f32_bf16 v10, v62, s48, v10
    v_dot2_f32_bf16 v11, v62, v62, v11
    v_dot2_f32_bf16 v10, v63, s48, v10
    v_dot2_f32_bf16 v11, v63, v63, v11
    v_dot2_f32_bf16 v10, v64, s48, v10
    v_dot2_f32_bf16 v11, v64, v64, v11
    v_dot2_f32_bf16 v10, v65, s48, v10
    v_dot2_f32_bf16 v11, v65, v65, v11
    v_dot2_f32_bf16 v10, v66, s48, v10
    v_dot2_f32_bf16 v11, v66, v66, v11
    v_dot2_f32_bf16 v10, v67, s48, v10
    v_dot2_f32_bf16 v11, v67, v67, v11
    v_dot2_f32_bf16 v10, v68, s48, v10
    v_dot2_f32_bf16 v11, v68, v68, v11
    v_dot2_f32_bf16 v10, v69, s48, v10
    v_dot2_f32_bf16 v11, v69, v69, v11
    v_dot2_f32_bf16 v10, v70, s48, v10
    v_dot2_f32_bf16 v11, v70, v70, v11
    v_dot2_f32_bf16 v10, v71, s48, v10
    v_dot2_f32_bf16 v11, v71, v71, v11
    v_dot2_f32_bf16 v10, v72, s48, v10
    v_dot2_f32_bf16 v11, v72, v72, v11
    v_dot2_f32_bf16 v10, v73, s48, v10
    v_dot2_f32_bf16 v11, v73, v73, v11
    v_dot2_f32_bf16 v10, v74, s48, v10
    v_dot2_f32_bf16 v11, v74, v74, v11
    v_dot2_f32_bf16 v10, v75, s48, v10
    v_dot2_f32_bf16 v11, v75, v75, v11
    v_dot2_f32_bf16 v10, v76, s48, v10
    v_dot2_f32_bf16 v11, v76, v76, v11
    v_dot2_f32_bf16 v10, v77, s48, v10
    v_dot2_f32_bf16 v11, v77, v77, v11
    v_dot2_f32_bf16 v10, v78, s48, v10
    v_dot2_f32_bf16 v11, v78, v78, v11
    v_dot2_f32_bf16 v10, v79, s48, v10
    v_dot2_f32_bf16 v11, v79, v79, v11
    v_dot2_f32_bf16 v10, v80, s48, v10
    v_dot2_f32_bf16 v11, v80, v80, v11
    v_dot2_f32_bf16 v10, v81, s48, v10
    v_dot2_f32_bf16 v11, v81, v81, v11
    v_dot2_f32_bf16 v10, v82, s48, v10
    v_dot2_f32_bf16 v11, v82, v82, v11
    v_dot2_f32_bf16 v10, v83, s48, v10
    v_dot2_f32_bf16 v11, v83, v83, v11
    v_dot2_f32_bf16 v10, v84, s48, v10
    v_dot2_f32_bf16 v11, v84, v84, v11
    v_dot2_f32_bf16 v10, v85, s48, v10
    v_dot2_f32_bf16 v11, v85, v85, v11
    v_dot2_f32_bf16 v10, v86, s48, v10
    v_dot2_f32_bf16 v11, v86, v86, v11
    v_dot2_f32_bf16 v10, v87, s48, v10
    v_dot2_f32_bf16 v11, v87, v87, v11
    ds_swizzle_b32 v88, v10 offset:1055
    ds_swizzle_b32 v89, v11 offset:1055
    s_waitcnt lgkmcnt(0)
    v_add_f32 v10, v10, v88
    v_add_f32 v11, v11, v89
    ds_swizzle_b32 v88, v10 offset:2079
    ds_swizzle_b32 v89, v11 offset:2079
    s_waitcnt lgkmcnt(0)
    v_add_f32 v10, v10, v88
    v_add_f32 v11, v11, v89
    ds_swizzle_b32 v88, v10 offset:4127
    ds_swizzle_b32 v89, v11 offset:4127
    s_waitcnt lgkmcnt(0)
    v_add_f32 v10, v10, v88
    v_add_f32 v11, v11, v89
    v_mul_f32 v10, 0x3b124925, v10
    v_mul_f32 v11, 0x3b124925, v11
    v_fma_f32 v11, -v10, v10, v11
    v_max_f32 v11, 0, v11
    v_add_f32 v11, 0x3727c5ac, v11
    v_rsq_f32 v11, v11
    s_nop 0
    v_mul_f32 v10, v10, v11
    v_sub_f32 v10, 0, v10
    v_lshlrev_b32 v88, 16, v60
    v_and_b32 v89, 0xffff0000, v60
    v_fma_f32 v88, v88, v11, v10
    v_fma_f32 v89, v89, v11, v10
    v_cvt_pk_bf16_f32 v60, v88, v89
    v_lshlrev_b32 v88, 16, v61
    v_and_b32 v89, 0xffff0000, v61
    v_fma_f32 v88, v88, v11, v10
    v_fma_f32 v89, v89, v11, v10
    v_cvt_pk_bf16_f32 v61, v88, v89
    v_lshlrev_b32 v88, 16, v62
    v_and_b32 v89, 0xffff0000, v62
    v_fma_f32 v88, v88, v11, v10
    v_fma_f32 v89, v89, v11, v10
    v_cvt_pk_bf16_f32 v62, v88, v89
    v_lshlrev_b32 v88, 16, v63
    v_and_b32 v89, 0xffff0000, v63
    v_fma_f32 v88, v88, v11, v10
    v_fma_f32 v89, v89, v11, v10
    v_cvt_pk_bf16_f32 v63, v88, v89
    v_lshlrev_b32 v88, 16, v64
    v_and_b32 v89, 0xffff0000, v64
    v_fma_f32 v88, v88, v11, v10
    v_fma_f32 v89, v89, v11, v10
    v_cvt_pk_bf16_f32 v64, v88, v89
    v_lshlrev_b32 v88, 16, v65
    v_and_b32 v89, 0xffff0000, v65
    v_fma_f32 v88, v88, v11, v10
    v_fma_f32 v89, v89, v11, v10
    v_cvt_pk_bf16_f32 v65, v88, v89
    v_lshlrev_b32 v88, 16, v66
    v_and_b32 v89, 0xffff0000, v66
    v_fma_f32 v88, v88, v11, v10
    v_fma_f32 v89, v89, v11, v10
    v_cvt_pk_bf16_f32 v66, v88, v89
    v_lshlrev_b32 v88, 16, v67
    v_and_b32 v89, 0xffff0000, v67
    v_fma_f32 v88, v88, v11, v10
    v_fma_f32 v89, v89, v11, v10
    v_cvt_pk_bf16_f32 v67, v88, v89
    v_lshlrev_b32 v88, 16, v68
    v_and_b32 v89, 0xffff0000, v68
    v_fma_f32 v88, v88, v11, v10
    v_fma_f32 v89, v89, v11, v10
    v_cvt_pk_bf16_f32 v68, v88, v89
    v_lshlrev_b32 v88, 16, v69
    v_and_b32 v89, 0xffff0000, v69
    v_fma_f32 v88, v88, v11, v10
    v_fma_f32 v89, v89, v11, v10
    v_cvt_pk_bf16_f32 v69, v88, v89
    v_lshlrev_b32 v88, 16, v70
    v_and_b32 v89, 0xffff0000, v70
    v_fma_f32 v88, v88, v11, v10
    v_fma_f32 v89, v89, v11, v10
    v_cvt_pk_bf16_f32 v70, v88, v89
    v_lshlrev_b32 v88, 16, v71
    v_and_b32 v89, 0xffff0000, v71
    v_fma_f32 v88, v88, v11, v10
    v_fma_f32 v89, v89, v11, v10
    v_cvt_pk_bf16_f32 v71, v88, v89
    v_lshlrev_b32 v88, 16, v72
    v_and_b32 v89, 0xffff0000, v72
    v_fma_f32 v88, v88, v11, v10
    v_fma_f32 v89, v89, v11, v10
    v_cvt_pk_bf16_f32 v72, v88, v89
    v_lshlrev_b32 v88, 16, v73
    v_and_b32 v89, 0xffff0000, v73
    v_fma_f32 v88, v88, v11, v10
    v_fma_f32 v89, v89, v11, v10
    v_cvt_pk_bf16_f32 v73, v88, v89
    v_lshlrev_b32 v88, 16, v74
    v_and_b32 v89, 0xffff0000, v74
    v_fma_f32 v88, v88, v11, v10
    v_fma_f32 v89, v89, v11, v10
    v_cvt_pk_bf16_f32 v74, v88, v89
    v_lshlrev_b32 v88, 16, v75
    v_and_b32 v89, 0xffff0000, v75
    v_fma_f32 v88, v88, v11, v10
    v_fma_f32 v89, v89, v11, v10
    v_cvt_pk_bf16_f32 v75, v88, v89
    v_lshlrev_b32 v88, 16, v76
    v_and_b32 v89, 0xffff0000, v76
    v_fma_f32 v88, v88, v11, v10
    v_fma_f32 v89, v89, v11, v10
    v_cvt_pk_bf16_f32 v76, v88, v89
    v_lshlrev_b32 v88, 16, v77
    v_and_b32 v89, 0xffff0000, v77
    v_fma_f32 v88, v88, v11, v10
    v_fma_f32 v89, v89, v11, v10
    v_cvt_pk_bf16_f32 v77, v88, v89
    v_lshlrev_b32 v88, 16, v78
    v_and_b32 v89, 0xffff0000, v78
    v_fma_f32 v88, v88, v11, v10
    v_fma_f32 v89, v89, v11, v10
    v_cvt_pk_bf16_f32 v78, v88, v89
    v_lshlrev_b32 v88, 16, v79
    v_and_b32 v89, 0xffff0000, v79
    v_fma_f32 v88, v88, v11, v10
    v_fma_f32 v89, v89, v11, v10
    v_cvt_pk_bf16_f32 v79, v88, v89
    v_lshlrev_b32 v88, 16, v80
    v_and_b32 v89, 0xffff0000, v80
    v_fma_f32 v88, v88, v11, v10
    v_fma_f32 v89, v89, v11, v10
    v_cvt_pk_bf16_f32 v80, v88, v89
    v_lshlrev_b32 v88, 16, v81
    v_and_b32 v89, 0xffff0000, v81
    v_fma_f32 v88, v88, v11, v10
    v_fma_f32 v89, v89, v11, v10
    v_cvt_pk_bf16_f32 v81, v88, v89
    v_lshlrev_b32 v88, 16, v82
    v_and_b32 v89, 0xffff0000, v82
    v_fma_f32 v88, v88, v11, v10
    v_fma_f32 v89, v89, v11, v10
    v_cvt_pk_bf16_f32 v82, v88, v89
    v_lshlrev_b32 v88, 16, v83
    v_and_b32 v89, 0xffff0000, v83
    v_fma_f32 v88, v88, v11, v10
    v_fma_f32 v89, v89, v11, v10
    v_cvt_pk_bf16_f32 v83, v88, v89
    v_lshlrev_b32 v88, 16, v84
    v_and_b32 v89, 0xffff0000, v84
    v_fma_f32 v88, v88, v11, v10
    v_fma_f32 v89, v89, v11, v10
    v_cvt_pk_bf16_f32 v84, v88, v89
    v_lshlrev_b32 v88, 16, v85
    v_and_b32 v89, 0xffff0000, v85
    v_fma_f32 v88, v88, v11, v10
    v_fma_f32 v89, v89, v11, v10
    v_cvt_pk_bf16_f32 v85, v88, v89
    v_lshlrev_b32 v88, 16, v86
    v_and_b32 v89, 0xffff0000, v86
    v_fma_f32 v88, v88, v11, v10
    v_fma_f32 v89, v89, v11, v10
    v_cvt_pk_bf16_f32 v86, v88, v89
    v_lshlrev_b32 v88, 16, v87
    v_and_b32 v89, 0xffff0000, v87
    v_fma_f32 v88, v88, v11, v10
    v_fma_f32 v89, v89, v11, v10
    v_cvt_pk_bf16_f32 v87, v88, v89
    ds_write_b128 v9, v[60:63] offset:7424
    ds_write_b128 v9, v[64:67] offset:7552
    ds_write_b128 v9, v[68:71] offset:7680
    ds_write_b128 v9, v[72:75] offset:7808
    ds_write_b128 v9, v[76:79] offset:7936
    ds_write_b128 v9, v[80:83] offset:8064
    ds_write_b128 v9, v[84:87] offset:8192
    s_waitcnt vmcnt(4)
    s_mov_b64 exec, s[40:41]
    ds_write_b128 v3, v[16:19] offset:0
    ds_write_b128 v3, v[20:23] offset:224
    s_mov_b64 exec, s[42:43]
    ds_write_b64 v15, v[26:27] offset:0
    s_mov_b64 exec, -1
    ds_write_b64 v13, v[24:25] offset:0
    s_add_u32 s44, s44, 114688
    s_add_u32 s45, s45, 86016
    s_mov_b64 exec, s[40:41]
    buffer_load_dwordx4 v[16:19], v2, s[24:27], s44 offen
    buffer_load_dwordx4 v[20:23], v2, s[28:31], s44 offen
    s_mov_b64 exec, s[42:43]
    buffer_load_dwordx2 v[26:27], v14, s[20:23], s45 offen
    s_mov_b64 exec, -1
    buffer_load_dwordx2 v[24:25], v12, s[20:23], s45 offen
    s_waitcnt vmcnt(4)
    s_mov_b64 exec, s[40:41]
    ds_write_b128 v3, v[180:183] offset:22528
    ds_write_b128 v3, v[184:187] offset:22752
    s_mov_b64 exec, s[42:43]
    ds_write_b64 v15, v[190:191] offset:22528
    s_mov_b64 exec, -1
    ds_write_b64 v13, v[188:189] offset:22528
    s_add_u32 s44, s44, 114688
    s_add_u32 s45, s45, 86016
    s_mov_b64 exec, s[40:41]
    buffer_load_dwordx4 v[180:183], v2, s[24:27], s44 offen
    buffer_load_dwordx4 v[184:187], v2, s[28:31], s44 offen
    s_mov_b64 exec, s[42:43]
    buffer_load_dwordx2 v[190:191], v14, s[20:23], s45 offen
    s_mov_b64 exec, -1
    buffer_load_dwordx2 v[188:189], v12, s[20:23], s45 offen
    s_waitcnt lgkmcnt(0)
    s_barrier
    s_and_b32 s49, s14, 3
    v_and_b32 v6, 15, v1
    v_lshrrev_b32 v7, 4, v1
    s_lshl_b32 s47, s49, 5
    v_add_u32 v8, s47, v6
    v_mul_u32_u24 v8, 928, v8
    v_lshlrev_b32 v9, 4, v7
    v_add_u32 v4, v8, v9
    v_lshlrev_b32 v8, 3, v7
    v_lshrrev_b32 v9, 2, v6
    v_add_u32 v8, v8, v9
    v_mul_u32_u24 v9, 704, v8
    v_and_b32 v8, 8, v8
    v_lshlrev_b32 v8, 2, v8
    v_add_u32 v9, v9, v8
    v_and_b32 v8, 3, v6
    v_lshlrev_b32 v8, 3, v8
    v_add_u32 v9, v9, v8
    v_add_u32 v5, 118784, v9
    v_mov_b32 v100, 0
    v_mov_b32 v101, 0
    v_mov_b32 v102, 0
    v_mov_b32 v103, 0
    v_mov_b32 v104, 0
    v_mov_b32 v105, 0
    v_mov_b32 v106, 0
    v_mov_b32 v107, 0
    v_mov_b32 v108, 0
    v_mov_b32 v109, 0
    v_mov_b32 v110, 0
    v_mov_b32 v111, 0
    v_mov_b32 v112, 0
    v_mov_b32 v113, 0
    v_mov_b32 v114, 0
    v_mov_b32 v115, 0
    v_mov_b32 v116, 0
    v_mov_b32 v117, 0
    v_mov_b32 v118, 0
    v_mov_b32 v119, 0
    v_mov_b32 v120, 0
    v_mov_b32 v121, 0
    v_mov_b32 v122, 0
    v_mov_b32 v123, 0
    v_mov_b32 v124, 0
    v_mov_b32 v125, 0
    v_mov_b32 v126, 0
    v_mov_b32 v127, 0
    v_mov_b32 v128, 0
    v_mov_b32 v129, 0
    v_mov_b32 v130, 0
    v_mov_b32 v131, 0
    v_mov_b32 v132, 0
    v_mov_b32 v133, 0
    v_mov_b32 v134, 0
    v_mov_b32 v135, 0
    v_mov_b32 v136, 0
    v_mov_b32 v137, 0
    v_mov_b32 v138, 0
    v_mov_b32 v139, 0
    v_mov_b32 v140, 0
    v_mov_b32 v141, 0
    v_mov_b32 v142, 0
    v_mov_b32 v143, 0
    v_mov_b32 v144, 0
    v_mov_b32 v145, 0
    v_mov_b32 v146, 0
    v_mov_b32 v147, 0
    v_mov_b32 v148, 0
    v_mov_b32 v149, 0
    v_mov_b32 v150, 0
    v_mov_b32 v151, 0
    v_mov_b32 v152, 0
    v_mov_b32 v153, 0
    v_mov_b32 v154, 0
    v_mov_b32 v155, 0
    v_mov_b32 v156, 0
    v_mov_b32 v157, 0
    v_mov_b32 v158, 0
    v_mov_b32 v159, 0
    v_mov_b32 v160, 0
    v_mov_b32 v161, 0
    v_mov_b32 v162, 0
    v_mov_b32 v163, 0
    v_mov_b32 v164, 0
    v_mov_b32 v165, 0
    v_mov_b32 v166, 0
    v_mov_b32 v167, 0
    v_mov_b32 v168, 0
    v_mov_b32 v169, 0
    v_mov_b32 v170, 0
    v_mov_b32 v171, 0
    v_mov_b32 v172, 0
    v_mov_b32 v173, 0
    v_mov_b32 v174, 0
    v_mov_b32 v175, 0
    v_mov_b32 v176, 0
    v_mov_b32 v177, 0
    v_mov_b32 v178, 0
    v_mov_b32 v179, 0
    s_cmp_ge_u32 s14, 4
    s_cbranch_scc1 k1_wn1
    ds_read_b128 v[28:31], v4 offset:0
    ds_read_b128 v[32:35], v4 offset:14848
    ds_read_b64_tr_b16 v[36:37], v5 offset:0
    ds_read_b64_tr_b16 v[38:39], v5 offset:2816
    ds_read_b64_tr_b16 v[40:41], v5 offset:32
    ds_read_b64_tr_b16 v[42:43], v5 offset:2848
    ds_read_b64_tr_b16 v[44:45], v5 offset:64
    ds_read_b64_tr_b16 v[46:47], v5 offset:2880
    ds_read_b64_tr_b16 v[48:49], v5 offset:96
    ds_read_b64_tr_b16 v[50:51], v5 offset:2912
    ds_read_b64_tr_b16 v[52:53], v5 offset:128
    ds_read_b64_tr_b16 v[54:55], v5 offset:2944
    ds_read_b64_tr_b16 v[56:57], v5 offset:160
    ds_read_b64_tr_b16 v[58:59], v5 offset:2976
    ds_read_b64_tr_b16 v[60:61], v5 offset:192
    ds_read_b64_tr_b16 v[62:63], v5 offset:3008
    ds_read_b64_tr_b16 v[64:65], v5 offset:224
    ds_read_b64_tr_b16 v[66:67], v5 offset:3040
    ds_read_b64_tr_b16 v[68:69], v5 offset:416
    ds_read_b64_tr_b16 v[70:71], v5 offset:3232
    ds_read_b64_tr_b16 v[72:73], v5 offset:448
    ds_read_b64_tr_b16 v[74:75], v5 offset:3264
    s_waitcnt lgkmcnt(0)
    s_barrier
    s_mov_b32 s52, 0
k1_loop4:
    v_mfma_f32_16x16x32_bf16 v[100:103], v[36:39], v[28:31], v[100:103]
    ds_read_b128 v[192:195], v4 offset:64
    ds_read_b128 v[196:199], v4 offset:14912
    v_mfma_f32_16x16x32_bf16 v[104:107], v[36:39], v[32:35], v[104:107]
    ds_read_b64_tr_b16 v[200:201], v5 offset:22528
    ds_read_b64_tr_b16 v[202:203], v5 offset:25344
    v_mfma_f32_16x16x32_bf16 v[108:111], v[40:43], v[28:31], v[108:111]
    ds_read_b64_tr_b16 v[204:205], v5 offset:22560
    v_mfma_f32_16x16x32_bf16 v[112:115], v[40:43], v[32:35], v[112:115]
    ds_read_b64_tr_b16 v[206:207], v5 offset:25376
    v_mfma_f32_16x16x32_bf16 v[116:119], v[28:31], v[44:47], v[116:119]
    ds_read_b64_tr_b16 v[208:209], v5 offset:22592
    v_mfma_f32_16x16x32_bf16 v[120:123], v[32:35], v[44:47], v[120:123]
    ds_read_b64_tr_b16 v[210:211], v5 offset:25408
    v_mfma_f32_16x16x32_bf16 v[124:127], v[28:31], v[48:51], v[124:127]
    ds_read_b64_tr_b16 v[212:213], v5 offset:22624
    v_mfma_f32_16x16x32_bf16 v[128:131], v[32:35], v[48:51], v[128:131]
    ds_read_b64_tr_b16 v[214:215], v5 offset:25440
    v_mfma_f32_16x16x32_bf16 v[132:135], v[28:31], v[52:55], v[132:135]
    ds_read_b64_tr_b16 v[216:217], v5 offset:22656
    v_mfma_f32_16x16x32_bf16 v[136:139], v[32:35], v[52:55], v[136:139]
    ds_read_b64_tr_b16 v[218:219], v5 offset:25472
    v_mfma_f32_16x16x32_bf16 v[140:143], v[28:31], v[56:59], v[140:143]
    ds_read_b64_tr_b16 v[220:221], v5 offset:22688
    v_mfma_f32_16x16x32_bf16 v[144:147], v[32:35], v[56:59], v[144:147]
    ds_read_b64_tr_b16 v[222:223], v5 offset:25504
    v_mfma_f32_16x16x32_bf16 v[148:151], v[60:63], v[28:31], v[148:151]
    ds_read_b64_tr_b16 v[224:225], v5 offset:22720
    v_mfma_f32_16x16x32_bf16 v[152:155], v[60:63], v[32:35], v[152:155]
    ds_read_b64_tr_b16 v[226:227], v5 offset:25536
    s_waitcnt vmcnt(4)
    s_mov_b64 exec, s[40:41]
    ds_write_b128 v3, v[16:19] offset:0
    ds_write_b128 v3, v[20:23] offset:224
    s_mov_b64 exec, s[42:43]
    ds_write_b64 v15, v[26:27] offset:0
    s_mov_b64 exec, -1
    ds_write_b64 v13, v[24:25] offset:0
    s_add_u32 s44, s44, 114688
    s_add_u32 s45, s45, 86016
    s_mov_b64 exec, s[40:41]
    buffer_load_dwordx4 v[16:19], v2, s[24:27], s44 offen
    buffer_load_dwordx4 v[20:23], v2, s[28:31], s44 offen
    s_mov_b64 exec, s[42:43]
    buffer_load_dwordx2 v[26:27], v14, s[20:23], s45 offen
    s_mov_b64 exec, -1
    buffer_load_dwordx2 v[24:25], v12, s[20:23], s45 offen
    v_mfma_f32_16x16x32_bf16 v[156:159], v[64:67], v[28:31], v[156:159]
    ds_read_b64_tr_b16 v[228:229], v5 offset:22752
    v_mfma_f32_16x16x32_bf16 v[160:163], v[64:67], v[32:35], v[160:163]
    ds_read_b64_tr_b16 v[230:231], v5 offset:25568
    v_mfma_f32_16x16x32_bf16 v[164:167], v[68:71], v[28:31], v[164:167]
    ds_read_b64_tr_b16 v[232:233], v5 offset:22944
    v_mfma_f32_16x16x32_bf16 v[168:171], v[68:71], v[32:35], v[168:171]
    ds_read_b64_tr_b16 v[234:235], v5 offset:25760
    v_mfma_f32_16x16x32_bf16 v[172:175], v[72:75], v[28:31], v[172:175]
    ds_read_b64_tr_b16 v[236:237], v5 offset:22976
    v_mfma_f32_16x16x32_bf16 v[176:179], v[72:75], v[32:35], v[176:179]
    ds_read_b64_tr_b16 v[238:239], v5 offset:25792
    s_waitcnt lgkmcnt(0)
    s_barrier
    v_add_u32 v4, 128, v4
    v_mfma_f32_16x16x32_bf16 v[100:103], v[200:203], v[192:195], v[100:103]
    ds_read_b128 v[28:31], v4 offset:0
    ds_read_b128 v[32:35], v4 offset:14848
    v_mfma_f32_16x16x32_bf16 v[104:107], v[200:203], v[196:199], v[104:107]
    ds_read_b64_tr_b16 v[36:37], v5 offset:0
    ds_read_b64_tr_b16 v[38:39], v5 offset:2816
    v_mfma_f32_16x16x32_bf16 v[108:111], v[204:207], v[192:195], v[108:111]
    ds_read_b64_tr_b16 v[40:41], v5 offset:32
    v_mfma_f32_16x16x32_bf16 v[112:115], v[204:207], v[196:199], v[112:115]
    ds_read_b64_tr_b16 v[42:43], v5 offset:2848
    v_mfma_f32_16x16x32_bf16 v[116:119], v[192:195], v[208:211], v[116:119]
    ds_read_b64_tr_b16 v[44:45], v5 offset:64
    v_mfma_f32_16x16x32_bf16 v[120:123], v[196:199], v[208:211], v[120:123]
    ds_read_b64_tr_b16 v[46:47], v5 offset:2880
    v_mfma_f32_16x16x32_bf16 v[124:127], v[192:195], v[212:215], v[124:127]
    ds_read_b64_tr_b16 v[48:49], v5 offset:96
    v_mfma_f32_16x16x32_bf16 v[128:131], v[196:199], v[212:215], v[128:131]
    ds_read_b64_tr_b16 v[50:51], v5 offset:2912
    v_mfma_f32_16x16x32_bf16 v[132:135], v[192:195], v[216:219], v[132:135]
    ds_read_b64_tr_b16 v[52:53], v5 offset:128
    v_mfma_f32_16x16x32_bf16 v[136:139], v[196:199], v[216:219], v[136:139]
    ds_read_b64_tr_b16 v[54:55], v5 offset:2944
    v_mfma_f32_16x16x32_bf16 v[140:143], v[192:195], v[220:223], v[140:143]
    ds_read_b64_tr_b16 v[56:57], v5 offset:160
    v_mfma_f32_16x16x32_bf16 v[144:147], v[196:199], v[220:223], v[144:147]
    ds_read_b64_tr_b16 v[58:59], v5 offset:2976
    v_mfma_f32_16x16x32_bf16 v[148:151], v[224:227], v[192:195], v[148:151]
    ds_read_b64_tr_b16 v[60:61], v5 offset:192
    v_mfma_f32_16x16x32_bf16 v[152:155], v[224:227], v[196:199], v[152:155]
    ds_read_b64_tr_b16 v[62:63], v5 offset:3008
    s_waitcnt vmcnt(4)
    s_mov_b64 exec, s[40:41]
    ds_write_b128 v3, v[180:183] offset:22528
    ds_write_b128 v3, v[184:187] offset:22752
    s_mov_b64 exec, s[42:43]
    ds_write_b64 v15, v[190:191] offset:22528
    s_mov_b64 exec, -1
    ds_write_b64 v13, v[188:189] offset:22528
    s_add_u32 s44, s44, 114688
    s_add_u32 s45, s45, 86016
    s_mov_b64 exec, s[40:41]
    buffer_load_dwordx4 v[180:183], v2, s[24:27], s44 offen
    buffer_load_dwordx4 v[184:187], v2, s[28:31], s44 offen
    s_mov_b64 exec, s[42:43]
    buffer_load_dwordx2 v[190:191], v14, s[20:23], s45 offen
    s_mov_b64 exec, -1
    buffer_load_dwordx2 v[188:189], v12, s[20:23], s45 offen
    v_mfma_f32_16x16x32_bf16 v[156:159], v[228:231], v[192:195], v[156:159]
    ds_read_b64_tr_b16 v[64:65], v5 offset:224
    v_mfma_f32_16x16x32_bf16 v[160:163], v[228:231], v[196:199], v[160:163]
    ds_read_b64_tr_b16 v[66:67], v5 offset:3040
    v_mfma_f32_16x16x32_bf16 v[164:167], v[232:235], v[192:195], v[164:167]
    ds_read_b64_tr_b16 v[68:69], v5 offset:416
    v_mfma_f32_16x16x32_bf16 v[168:171], v[232:235], v[196:199], v[168:171]
    ds_read_b64_tr_b16 v[70:71], v5 offset:3232
    v_mfma_f32_16x16x32_bf16 v[172:175], v[236:239], v[192:195], v[172:175]
    ds_read_b64_tr_b16 v[72:73], v5 offset:448
    v_mfma_f32_16x16x32_bf16 v[176:179], v[236:239], v[196:199], v[176:179]
    ds_read_b64_tr_b16 v[74:75], v5 offset:3264
    s_waitcnt lgkmcnt(0)
    s_barrier
    s_add_u32 s52, s52, 1
    s_cmp_lt_u32 s52, 7
    s_cbranch_scc1 k1_loop4
    s_nop 7
    s_nop 1
    v_and_b32 v6, 15, v1
    v_lshrrev_b32 v7, 4, v1
    s_lshl_b32 s46, s3, 7
    s_lshl_b32 s47, s49, 5
    s_add_u32 s46, s46, s47
    v_add_u32 v8, s46, v6
    v_mul_u32_u24 v90, 3584, v8
    v_lshlrev_b32 v9, 3, v7
    v_add_u32 v90, v90, v9
    s_mul_i32 s47, s2, 224
    v_add_u32 v90, s47, v90
    v_add_u32 v91, 57344, v90
    v_mul_f32 v94, 0xbfb8aa3b, v148
    v_mul_f32 v95, 0xbfb8aa3b, v149
    v_mul_f32 v96, 0xbfb8aa3b, v150
    v_mul_f32 v97, 0xbfb8aa3b, v151
    v_exp_f32 v94, v94
    v_exp_f32 v95, v95
    v_exp_f32 v96, v96
    v_exp_f32 v97, v97
    v_add_f32 v94, 1.0, v94
    v_add_f32 v95, 1.0, v95
    v_add_f32 v96, 1.0, v96
    v_add_f32 v97, 1.0, v97
    v_rcp_f32 v94, v94
    v_rcp_f32 v95, v95
    v_rcp_f32 v96, v96
    v_rcp_f32 v97, v97
    v_mul_f32 v94, v94, v148
    v_mul_f32 v95, v95, v149
    v_mul_f32 v96, v96, v150
    v_mul_f32 v97, v97, v151
    v_mul_f32 v148, v94, v164
    v_mul_f32 v149, v95, v165
    v_mul_f32 v150, v96, v166
    v_mul_f32 v151, v97, v167
    v_cvt_pk_bf16_f32 v148, v148, v149
    v_cvt_pk_bf16_f32 v149, v150, v151
    buffer_store_dwordx2 v[148:149], v90, s[32:35], 0 offen offset:0
    v_mul_f32 v94, 0xbfb8aa3b, v152
    v_mul_f32 v95, 0xbfb8aa3b, v153
    v_mul_f32 v96, 0xbfb8aa3b, v154
    v_mul_f32 v97, 0xbfb8aa3b, v155
    v_exp_f32 v94, v94
    v_exp_f32 v95, v95
    v_exp_f32 v96, v96
    v_exp_f32 v97, v97
    v_add_f32 v94, 1.0, v94
    v_add_f32 v95, 1.0, v95
    v_add_f32 v96, 1.0, v96
    v_add_f32 v97, 1.0, v97
    v_rcp_f32 v94, v94
    v_rcp_f32 v95, v95
    v_rcp_f32 v96, v96
    v_rcp_f32 v97, v97
    v_mul_f32 v94, v94, v152
    v_mul_f32 v95, v95, v153
    v_mul_f32 v96, v96, v154
    v_mul_f32 v97, v97, v155
    v_mul_f32 v152, v94, v168
    v_mul_f32 v153, v95, v169
    v_mul_f32 v154, v96, v170
    v_mul_f32 v155, v97, v171
    v_cvt_pk_bf16_f32 v152, v152, v153
    v_cvt_pk_bf16_f32 v153, v154, v155
    buffer_store_dwordx2 v[152:153], v91, s[32:35], 0 offen offset:0
    v_mul_f32 v94, 0xbfb8aa3b, v156
    v_mul_f32 v95, 0xbfb8aa3b, v157
    v_mul_f32 v96, 0xbfb8aa3b, v158
    v_mul_f32 v97, 0xbfb8aa3b, v159
    v_exp_f32 v94, v94
    v_exp_f32 v95, v95
    v_exp_f32 v96, v96
    v_exp_f32 v97, v97
    v_add_f32 v94, 1.0, v94
    v_add_f32 v95, 1.0, v95
    v_add_f32 v96, 1.0, v96
    v_add_f32 v97, 1.0, v97
    v_rcp_f32 v94, v94
    v_rcp_f32 v95, v95
    v_rcp_f32 v96, v96
    v_rcp_f32 v97, v97
    v_mul_f32 v94, v94, v156
    v_mul_f32 v95, v95, v157
    v_mul_f32 v96, v96, v158
    v_mul_f32 v97, v97, v159
    v_mul_f32 v156, v94, v172
    v_mul_f32 v157, v95, v173
    v_mul_f32 v158, v96, v174
    v_mul_f32 v159, v97, v175
    v_cvt_pk_bf16_f32 v156, v156, v157
    v_cvt_pk_bf16_f32 v157, v158, v159
    buffer_store_dwordx2 v[156:157], v90, s[32:35], 0 offen offset:32
    v_mul_f32 v94, 0xbfb8aa3b, v160
    v_mul_f32 v95, 0xbfb8aa3b, v161
    v_mul_f32 v96, 0xbfb8aa3b, v162
    v_mul_f32 v97, 0xbfb8aa3b, v163
    v_exp_f32 v94, v94
    v_exp_f32 v95, v95
    v_exp_f32 v96, v96
    v_exp_f32 v97, v97
    v_add_f32 v94, 1.0, v94
    v_add_f32 v95, 1.0, v95
    v_add_f32 v96, 1.0, v96
    v_add_f32 v97, 1.0, v97
    v_rcp_f32 v94, v94
    v_rcp_f32 v95, v95
    v_rcp_f32 v96, v96
    v_rcp_f32 v97, v97
    v_mul_f32 v94, v94, v160
    v_mul_f32 v95, v95, v161
    v_mul_f32 v96, v96, v162
    v_mul_f32 v97, v97, v163
    v_mul_f32 v160, v94, v176
    v_mul_f32 v161, v95, v177
    v_mul_f32 v162, v96, v178
    v_mul_f32 v163, v97, v179
    v_cvt_pk_bf16_f32 v160, v160, v161
    v_cvt_pk_bf16_f32 v161, v162, v163
    buffer_store_dwordx2 v[160:161], v91, s[32:35], 0 offen offset:32
    v_mul_u32_u24 v92, 896, v8
    v_add_u32 v92, v92, v9
    s_mul_i32 s47, s2, 56
    v_add_u32 v92, s47, v92
    v_add_u32 v92, 8388608, v92
    v_add_u32 v93, 14336, v92
    v_mul_f32 v94, 0x3fb8aa3b, v100
    v_mul_f32 v95, 0x3fb8aa3b, v101
    v_mul_f32 v96, 0x3fb8aa3b, v102
    v_mul_f32 v97, 0x3fb8aa3b, v103
    v_exp_f32 v94, v94
    v_exp_f32 v95, v95
    v_exp_f32 v96, v96
    v_exp_f32 v97, v97
    v_cmp_lt_f32 s[62:63], 0, v100
    v_cmp_lt_f32 s[64:65], 0, v101
    v_cmp_lt_f32 s[66:67], 0, v102
    v_cmp_lt_f32 s[68:69], 0, v103
    v_add_f32 v100, 1.0, v100
    v_add_f32 v101, 1.0, v101
    v_add_f32 v102, 1.0, v102
    v_add_f32 v103, 1.0, v103
    v_cndmask_b32 v100, v94, v100, s[62:63]
    v_cndmask_b32 v101, v95, v101, s[64:65]
    v_cndmask_b32 v102, v96, v102, s[66:67]
    v_cndmask_b32 v103, v97, v103, s[68:69]
    v_add_f32 v100, 0x358637bd, v100
    v_add_f32 v101, 0x358637bd, v101
    v_add_f32 v102, 0x358637bd, v102
    v_add_f32 v103, 0x358637bd, v103
    v_cvt_pk_bf16_f32 v100, v100, v101
    v_cvt_pk_bf16_f32 v101, v102, v103
    buffer_store_dwordx2 v[100:101], v92, s[32:35], 0 offen offset:0
    v_mul_f32 v94, 0x3fb8aa3b, v104
    v_mul_f32 v95, 0x3fb8aa3b, v105
    v_mul_f32 v96, 0x3fb8aa3b, v106
    v_mul_f32 v97, 0x3fb8aa3b, v107
    v_exp_f32 v94, v94
    v_exp_f32 v95, v95
    v_exp_f32 v96, v96
    v_exp_f32 v97, v97
    v_cmp_lt_f32 s[62:63], 0, v104
    v_cmp_lt_f32 s[64:65], 0, v105
    v_cmp_lt_f32 s[66:67], 0, v106
    v_cmp_lt_f32 s[68:69], 0, v107
    v_add_f32 v104, 1.0, v104
    v_add_f32 v105, 1.0, v105
    v_add_f32 v106, 1.0, v106
    v_add_f32 v107, 1.0, v107
    v_cndmask_b32 v104, v94, v104, s[62:63]
    v_cndmask_b32 v105, v95, v105, s[64:65]
    v_cndmask_b32 v106, v96, v106, s[66:67]
    v_cndmask_b32 v107, v97, v107, s[68:69]
    v_add_f32 v104, 0x358637bd, v104
    v_add_f32 v105, 0x358637bd, v105
    v_add_f32 v106, 0x358637bd, v106
    v_add_f32 v107, 0x358637bd, v107
    v_cvt_pk_bf16_f32 v104, v104, v105
    v_cvt_pk_bf16_f32 v105, v106, v107
    buffer_store_dwordx2 v[104:105], v93, s[32:35], 0 offen offset:0
    v_mul_f32 v94, 0x3fb8aa3b, v108
    v_mul_f32 v95, 0x3fb8aa3b, v109
    v_mul_f32 v96, 0x3fb8aa3b, v110
    v_mul_f32 v97, 0x3fb8aa3b, v111
    v_exp_f32 v94, v94
    v_exp_f32 v95, v95
    v_exp_f32 v96, v96
    v_exp_f32 v97, v97
    v_cmp_lt_f32 s[62:63], 0, v108
    v_cmp_lt_f32 s[64:65], 0, v109
    v_cmp_lt_f32 s[66:67], 0, v110
    v_cmp_lt_f32 s[68:69], 0, v111
    v_add_f32 v108, 1.0, v108
    v_add_f32 v109, 1.0, v109
    v_add_f32 v110, 1.0, v110
    v_add_f32 v111, 1.0, v111
    v_cndmask_b32 v108, v94, v108, s[62:63]
    v_cndmask_b32 v109, v95, v109, s[64:65]
    v_cndmask_b32 v110, v96, v110, s[66:67]
    v_cndmask_b32 v111, v97, v111, s[68:69]
    v_add_f32 v108, 0x358637bd, v108
    v_add_f32 v109, 0x358637bd, v109
    v_add_f32 v110, 0x358637bd, v110
    v_add_f32 v111, 0x358637bd, v111
    v_cvt_pk_bf16_f32 v108, v108, v109
    v_cvt_pk_bf16_f32 v109, v110, v111
    v_cmp_gt_u32 vcc, 48, v1
    s_and_saveexec_b64 s[38:39], vcc
    buffer_store_dwordx2 v[108:109], v92, s[32:35], 0 offen offset:32
    s_mov_b64 exec, s[38:39]
    v_mul_f32 v94, 0x3fb8aa3b, v112
    v_mul_f32 v95, 0x3fb8aa3b, v113
    v_mul_f32 v96, 0x3fb8aa3b, v114
    v_mul_f32 v97, 0x3fb8aa3b, v115
    v_exp_f32 v94, v94
    v_exp_f32 v95, v95
    v_exp_f32 v96, v96
    v_exp_f32 v97, v97
    v_cmp_lt_f32 s[62:63], 0, v112
    v_cmp_lt_f32 s[64:65], 0, v113
    v_cmp_lt_f32 s[66:67], 0, v114
    v_cmp_lt_f32 s[68:69], 0, v115
    v_add_f32 v112, 1.0, v112
    v_add_f32 v113, 1.0, v113
    v_add_f32 v114, 1.0, v114
    v_add_f32 v115, 1.0, v115
    v_cndmask_b32 v112, v94, v112, s[62:63]
    v_cndmask_b32 v113, v95, v113, s[64:65]
    v_cndmask_b32 v114, v96, v114, s[66:67]
    v_cndmask_b32 v115, v97, v115, s[68:69]
    v_add_f32 v112, 0x358637bd, v112
    v_add_f32 v113, 0x358637bd, v113
    v_add_f32 v114, 0x358637bd, v114
    v_add_f32 v115, 0x358637bd, v115
    v_cvt_pk_bf16_f32 v112, v112, v113
    v_cvt_pk_bf16_f32 v113, v114, v115
    v_cmp_gt_u32 vcc, 48, v1
    s_and_saveexec_b64 s[38:39], vcc
    buffer_store_dwordx2 v[112:113], v93, s[32:35], 0 offen offset:32
    s_mov_b64 exec, s[38:39]
    v_mul_f32 v94, 0x3fb8aa3b, v116
    v_mul_f32 v95, 0x3fb8aa3b, v117
    v_mul_f32 v96, 0x3fb8aa3b, v118
    v_mul_f32 v97, 0x3fb8aa3b, v119
    v_exp_f32 v94, v94
    v_exp_f32 v95, v95
    v_exp_f32 v96, v96
    v_exp_f32 v97, v97
    v_cmp_lt_f32 s[62:63], 0, v116
    v_cmp_lt_f32 s[64:65], 0, v117
    v_cmp_lt_f32 s[66:67], 0, v118
    v_cmp_lt_f32 s[68:69], 0, v119
    v_add_f32 v116, 1.0, v116
    v_add_f32 v117, 1.0, v117
    v_add_f32 v118, 1.0, v118
    v_add_f32 v119, 1.0, v119
    v_cndmask_b32 v116, v94, v116, s[62:63]
    v_cndmask_b32 v117, v95, v117, s[64:65]
    v_cndmask_b32 v118, v96, v118, s[66:67]
    v_cndmask_b32 v119, v97, v119, s[68:69]
    v_add_f32 v116, 0x358637bd, v116
    v_add_f32 v117, 0x358637bd, v117
    v_add_f32 v118, 0x358637bd, v118
    v_add_f32 v119, 0x358637bd, v119
    v_mul_f32 v94, 0x3fb8aa3b, v120
    v_mul_f32 v95, 0x3fb8aa3b, v121
    v_mul_f32 v96, 0x3fb8aa3b, v122
    v_mul_f32 v97, 0x3fb8aa3b, v123
    v_exp_f32 v94, v94
    v_exp_f32 v95, v95
    v_exp_f32 v96, v96
    v_exp_f32 v97, v97
    v_cmp_lt_f32 s[62:63], 0, v120
    v_cmp_lt_f32 s[64:65], 0, v121
    v_cmp_lt_f32 s[66:67], 0, v122
    v_cmp_lt_f32 s[68:69], 0, v123
    v_add_f32 v120, 1.0, v120
    v_add_f32 v121, 1.0, v121
    v_add_f32 v122, 1.0, v122
    v_add_f32 v123, 1.0, v123
    v_cndmask_b32 v120, v94, v120, s[62:63]
    v_cndmask_b32 v121, v95, v121, s[64:65]
    v_cndmask_b32 v122, v96, v122, s[66:67]
    v_cndmask_b32 v123, v97, v123, s[68:69]
    v_add_f32 v120, 0x358637bd, v120
    v_add_f32 v121, 0x358637bd, v121
    v_add_f32 v122, 0x358637bd, v122
    v_add_f32 v123, 0x358637bd, v123
    v_mul_f32 v94, 0x3fb8aa3b, v124
    v_mul_f32 v95, 0x3fb8aa3b, v125
    v_mul_f32 v96, 0x3fb8aa3b, v126
    v_mul_f32 v97, 0x3fb8aa3b, v127
    v_exp_f32 v94, v94
    v_exp_f32 v95, v95
    v_exp_f32 v96, v96
    v_exp_f32 v97, v97
    v_cmp_lt_f32 s[62:63], 0, v124
    v_cmp_lt_f32 s[64:65], 0, v125
    v_cmp_lt_f32 s[66:67], 0, v126
    v_cmp_lt_f32 s[68:69], 0, v127
    v_add_f32 v124, 1.0, v124
    v_add_f32 v125, 1.0, v125
    v_add_f32 v126, 1.0, v126
    v_add_f32 v127, 1.0, v127
    v_cndmask_b32 v124, v94, v124, s[62:63]
    v_cndmask_b32 v125, v95, v125, s[64:65]
    v_cndmask_b32 v126, v96, v126, s[66:67]
    v_cndmask_b32 v127, v97, v127, s[68:69]
    v_add_f32 v124, 0x358637bd, v124
    v_add_f32 v125, 0x358637bd, v125
    v_add_f32 v126, 0x358637bd, v126
    v_add_f32 v127, 0x358637bd, v127
    v_mul_f32 v94, 0x3fb8aa3b, v128
    v_mul_f32 v95, 0x3fb8aa3b, v129
    v_mul_f32 v96, 0x3fb8aa3b, v130
    v_mul_f32 v97, 0x3fb8aa3b, v131
    v_exp_f32 v94, v94
    v_exp_f32 v95, v95
    v_exp_f32 v96, v96
    v_exp_f32 v97, v97
    v_cmp_lt_f32 s[62:63], 0, v128
    v_cmp_lt_f32 s[64:65], 0, v129
    v_cmp_lt_f32 s[66:67], 0, v130
    v_cmp_lt_f32 s[68:69], 0, v131
    v_add_f32 v128, 1.0, v128
    v_add_f32 v129, 1.0, v129
    v_add_f32 v130, 1.0, v130
    v_add_f32 v131, 1.0, v131
    v_cndmask_b32 v128, v94, v128, s[62:63]
    v_cndmask_b32 v129, v95, v129, s[64:65]
    v_cndmask_b32 v130, v96, v130, s[66:67]
    v_cndmask_b32 v131, v97, v131, s[68:69]
    v_add_f32 v128, 0x358637bd, v128
    v_add_f32 v129, 0x358637bd, v129
    v_add_f32 v130, 0x358637bd, v130
    v_add_f32 v131, 0x358637bd, v131
    v_and_b32 v6, 15, v1
    v_cmp_eq_u32 vcc, 12, v6
    s_nop 1
    v_cndmask_b32 v140, v140, 1.0, vcc
    v_cndmask_b32 v141, v141, 1.0, vcc
    v_cndmask_b32 v142, v142, 1.0, vcc
    v_cndmask_b32 v143, v143, 1.0, vcc
    v_cndmask_b32 v144, v144, 1.0, vcc
    v_cndmask_b32 v145, v145, 1.0, vcc
    v_cndmask_b32 v146, v146, 1.0, vcc
    v_cndmask_b32 v147, v147, 1.0, vcc
    v_cvt_pk_bf16_f32 v28, v116, v117
    v_cvt_pk_bf16_f32 v29, v118, v119
    v_cvt_pk_bf16_f32 v30, v120, v121
    v_cvt_pk_bf16_f32 v31, v122, v123
    v_cvt_pk_bf16_f32 v32, v124, v125
    v_cvt_pk_bf16_f32 v33, v126, v127
    v_cvt_pk_bf16_f32 v34, v128, v129
    v_cvt_pk_bf16_f32 v35, v130, v131
    v_cvt_pk_bf16_f32 v36, v132, v133
    v_cvt_pk_bf16_f32 v37, v134, v135
    v_cvt_pk_bf16_f32 v38, v136, v137
    v_cvt_pk_bf16_f32 v39, v138, v139
    v_cvt_pk_bf16_f32 v40, v140, v141
    v_cvt_pk_bf16_f32 v41, v142, v143
    v_cvt_pk_bf16_f32 v42, v144, v145
    v_cvt_pk_bf16_f32 v43, v146, v147
    v_mov_b32 v48, 0
    v_mov_b32 v49, 0
    v_mov_b32 v50, 0
    v_mov_b32 v51, 0
    v_mov_b32 v52, 0
    v_mov_b32 v53, 0
    v_mov_b32 v54, 0
    v_mov_b32 v55, 0
    v_mov_b32 v56, 0
    v_mov_b32 v57, 0
    v_mov_b32 v58, 0
    v_mov_b32 v59, 0
    v_mov_b32 v60, 0
    v_mov_b32 v61, 0
    v_mov_b32 v62, 0
    v_mov_b32 v63, 0
    s_nop 1
    v_mfma_f32_16x16x32_bf16 v[48:51], v[28:31], v[36:39], v[48:51]
    v_mfma_f32_16x16x32_bf16 v[52:55], v[28:31], v[40:43], v[52:55]
    v_mfma_f32_16x16x32_bf16 v[56:59], v[32:35], v[36:39], v[56:59]
    v_mfma_f32_16x16x32_bf16 v[60:63], v[32:35], v[40:43], v[60:63]
    s_nop 7
    s_nop 1
    v_lshrrev_b32 v7, 4, v1
    v_lshlrev_b32 v7, 9, v7
    v_lshlrev_b32 v6, 2, v6
    v_add_u32 v7, v7, v6
    s_lshl_b32 s47, s49, 12
    v_add_u32 v7, s47, v7
    v_add_u32 v7, 118784, v7
    ds_write_b32 v7, v48 offset:0
    ds_write_b32 v7, v49 offset:128
    ds_write_b32 v7, v50 offset:256
    ds_write_b32 v7, v51 offset:384
    ds_write_b32 v7, v52 offset:64
    ds_write_b32 v7, v53 offset:192
    ds_write_b32 v7, v54 offset:320
    ds_write_b32 v7, v55 offset:448
    ds_write_b32 v7, v56 offset:2048
    ds_write_b32 v7, v57 offset:2176
    ds_write_b32 v7, v58 offset:2304
    ds_write_b32 v7, v59 offset:2432
    ds_write_b32 v7, v60 offset:2112
    ds_write_b32 v7, v61 offset:2240
    ds_write_b32 v7, v62 offset:2368
    ds_write_b32 v7, v63 offset:2496
    s_branch k1_red
k1_wn1:
    ds_read_b128 v[28:31], v4 offset:0
    ds_read_b128 v[32:35], v4 offset:14848
    ds_read_b64_tr_b16 v[36:37], v5 offset:256
    ds_read_b64_tr_b16 v[38:39], v5 offset:3072
    ds_read_b64_tr_b16 v[40:41], v5 offset:288
    ds_read_b64_tr_b16 v[42:43], v5 offset:3104
    ds_read_b64_tr_b16 v[44:45], v5 offset:320
    ds_read_b64_tr_b16 v[46:47], v5 offset:3136
    ds_read_b64_tr_b16 v[48:49], v5 offset:352
    ds_read_b64_tr_b16 v[50:51], v5 offset:3168
    ds_read_b64_tr_b16 v[52:53], v5 offset:384
    ds_read_b64_tr_b16 v[54:55], v5 offset:3200
    ds_read_b64_tr_b16 v[56:57], v5 offset:480
    ds_read_b64_tr_b16 v[58:59], v5 offset:3296
    ds_read_b64_tr_b16 v[60:61], v5 offset:512
    ds_read_b64_tr_b16 v[62:63], v5 offset:3328
    ds_read_b64_tr_b16 v[64:65], v5 offset:544
    ds_read_b64_tr_b16 v[66:67], v5 offset:3360
    ds_read_b64_tr_b16 v[68:69], v5 offset:576
    ds_read_b64_tr_b16 v[70:71], v5 offset:3392
    ds_read_b64_tr_b16 v[72:73], v5 offset:608
    ds_read_b64_tr_b16 v[74:75], v5 offset:3424
    s_waitcnt lgkmcnt(0)
    s_barrier
    s_mov_b32 s52, 0
k1_loop0:
    v_mfma_f32_16x16x32_bf16 v[100:103], v[36:39], v[28:31], v[100:103]
    ds_read_b128 v[192:195], v4 offset:64
    ds_read_b128 v[196:199], v4 offset:14912
    v_mfma_f32_16x16x32_bf16 v[104:107], v[36:39], v[32:35], v[104:107]
    ds_read_b64_tr_b16 v[200:201], v5 offset:22784
    ds_read_b64_tr_b16 v[202:203], v5 offset:25600
    v_mfma_f32_16x16x32_bf16 v[108:111], v[40:43], v[28:31], v[108:111]
    ds_read_b64_tr_b16 v[204:205], v5 offset:22816
    v_mfma_f32_16x16x32_bf16 v[112:115], v[40:43], v[32:35], v[112:115]
    ds_read_b64_tr_b16 v[206:207], v5 offset:25632
    v_mfma_f32_16x16x32_bf16 v[116:119], v[44:47], v[28:31], v[116:119]
    ds_read_b64_tr_b16 v[208:209], v5 offset:22848
    v_mfma_f32_16x16x32_bf16 v[120:123], v[44:47], v[32:35], v[120:123]
    ds_read_b64_tr_b16 v[210:211], v5 offset:25664
    v_mfma_f32_16x16x32_bf16 v[124:127], v[48:51], v[28:31], v[124:127]
    ds_read_b64_tr_b16 v[212:213], v5 offset:22880
    v_mfma_f32_16x16x32_bf16 v[128:131], v[48:51], v[32:35], v[128:131]
    ds_read_b64_tr_b16 v[214:215], v5 offset:25696
    v_mfma_f32_16x16x32_bf16 v[132:135], v[52:55], v[28:31], v[132:135]
    ds_read_b64_tr_b16 v[216:217], v5 offset:22912
    v_mfma_f32_16x16x32_bf16 v[136:139], v[52:55], v[32:35], v[136:139]
    ds_read_b64_tr_b16 v[218:219], v5 offset:25728
    v_mfma_f32_16x16x32_bf16 v[140:143], v[56:59], v[28:31], v[140:143]
    ds_read_b64_tr_b16 v[220:221], v5 offset:23008
    v_mfma_f32_16x16x32_bf16 v[144:147], v[56:59], v[32:35], v[144:147]
    ds_read_b64_tr_b16 v[222:223], v5 offset:25824
    v_mfma_f32_16x16x32_bf16 v[148:151], v[60:63], v[28:31], v[148:151]
    ds_read_b64_tr_b16 v[224:225], v5 offset:23040
    v_mfma_f32_16x16x32_bf16 v[152:155], v[60:63], v[32:35], v[152:155]
    ds_read_b64_tr_b16 v[226:227], v5 offset:25856
    s_waitcnt vmcnt(4)
    s_mov_b64 exec, s[40:41]
    ds_write_b128 v3, v[16:19] offset:0
    ds_write_b128 v3, v[20:23] offset:224
    s_mov_b64 exec, s[42:43]
    ds_write_b64 v15, v[26:27] offset:0
    s_mov_b64 exec, -1
    ds_write_b64 v13, v[24:25] offset:0
    s_add_u32 s44, s44, 114688
    s_add_u32 s45, s45, 86016
    s_mov_b64 exec, s[40:41]
    buffer_load_dwordx4 v[16:19], v2, s[24:27], s44 offen
    buffer_load_dwordx4 v[20:23], v2, s[28:31], s44 offen
    s_mov_b64 exec, s[42:43]
    buffer_load_dwordx2 v[26:27], v14, s[20:23], s45 offen
    s_mov_b64 exec, -1
    buffer_load_dwordx2 v[24:25], v12, s[20:23], s45 offen
    v_mfma_f32_16x16x32_bf16 v[156:159], v[64:67], v[28:31], v[156:159]
    ds_read_b64_tr_b16 v[228:229], v5 offset:23072
    v_mfma_f32_16x16x32_bf16 v[160:163], v[64:67], v[32:35], v[160:163]
    ds_read_b64_tr_b16 v[230:231], v5 offset:25888
    v_mfma_f32_16x16x32_bf16 v[164:167], v[68:71], v[28:31], v[164:167]
    ds_read_b64_tr_b16 v[232:233], v5 offset:23104
    v_mfma_f32_16x16x32_bf16 v[168:171], v[68:71], v[32:35], v[168:171]
    ds_read_b64_tr_b16 v[234:235], v5 offset:25920
    v_mfma_f32_16x16x32_bf16 v[172:175], v[72:75], v[28:31], v[172:175]
    ds_read_b64_tr_b16 v[236:237], v5 offset:23136
    v_mfma_f32_16x16x32_bf16 v[176:179], v[72:75], v[32:35], v[176:179]
    ds_read_b64_tr_b16 v[238:239], v5 offset:25952
    s_waitcnt lgkmcnt(0)
    s_barrier
    v_add_u32 v4, 128, v4
    v_mfma_f32_16x16x32_bf16 v[100:103], v[200:203], v[192:195], v[100:103]
    ds_read_b128 v[28:31], v4 offset:0
    ds_read_b128 v[32:35], v4 offset:14848
    v_mfma_f32_16x16x32_bf16 v[104:107], v[200:203], v[196:199], v[104:107]
    ds_read_b64_tr_b16 v[36:37], v5 offset:256
    ds_read_b64_tr_b16 v[38:39], v5 offset:3072
    v_mfma_f32_16x16x32_bf16 v[108:111], v[204:207], v[192:195], v[108:111]
    ds_read_b64_tr_b16 v[40:41], v5 offset:288
    v_mfma_f32_16x16x32_bf16 v[112:115], v[204:207], v[196:199], v[112:115]
    ds_read_b64_tr_b16 v[42:43], v5 offset:3104
    v_mfma_f32_16x16x32_bf16 v[116:119], v[208:211], v[192:195], v[116:119]
    ds_read_b64_tr_b16 v[44:45], v5 offset:320
    v_mfma_f32_16x16x32_bf16 v[120:123], v[208:211], v[196:199], v[120:123]
    ds_read_b64_tr_b16 v[46:47], v5 offset:3136
    v_mfma_f32_16x16x32_bf16 v[124:127], v[212:215], v[192:195], v[124:127]
    ds_read_b64_tr_b16 v[48:49], v5 offset:352
    v_mfma_f32_16x16x32_bf16 v[128:131], v[212:215], v[196:199], v[128:131]
    ds_read_b64_tr_b16 v[50:51], v5 offset:3168
    v_mfma_f32_16x16x32_bf16 v[132:135], v[216:219], v[192:195], v[132:135]
    ds_read_b64_tr_b16 v[52:53], v5 offset:384
    v_mfma_f32_16x16x32_bf16 v[136:139], v[216:219], v[196:199], v[136:139]
    ds_read_b64_tr_b16 v[54:55], v5 offset:3200
    v_mfma_f32_16x16x32_bf16 v[140:143], v[220:223], v[192:195], v[140:143]
    ds_read_b64_tr_b16 v[56:57], v5 offset:480
    v_mfma_f32_16x16x32_bf16 v[144:147], v[220:223], v[196:199], v[144:147]
    ds_read_b64_tr_b16 v[58:59], v5 offset:3296
    v_mfma_f32_16x16x32_bf16 v[148:151], v[224:227], v[192:195], v[148:151]
    ds_read_b64_tr_b16 v[60:61], v5 offset:512
    v_mfma_f32_16x16x32_bf16 v[152:155], v[224:227], v[196:199], v[152:155]
    ds_read_b64_tr_b16 v[62:63], v5 offset:3328
    s_waitcnt vmcnt(4)
    s_mov_b64 exec, s[40:41]
    ds_write_b128 v3, v[180:183] offset:22528
    ds_write_b128 v3, v[184:187] offset:22752
    s_mov_b64 exec, s[42:43]
    ds_write_b64 v15, v[190:191] offset:22528
    s_mov_b64 exec, -1
    ds_write_b64 v13, v[188:189] offset:22528
    s_add_u32 s44, s44, 114688
    s_add_u32 s45, s45, 86016
    s_mov_b64 exec, s[40:41]
    buffer_load_dwordx4 v[180:183], v2, s[24:27], s44 offen
    buffer_load_dwordx4 v[184:187], v2, s[28:31], s44 offen
    s_mov_b64 exec, s[42:43]
    buffer_load_dwordx2 v[190:191], v14, s[20:23], s45 offen
    s_mov_b64 exec, -1
    buffer_load_dwordx2 v[188:189], v12, s[20:23], s45 offen
    v_mfma_f32_16x16x32_bf16 v[156:159], v[228:231], v[192:195], v[156:159]
    ds_read_b64_tr_b16 v[64:65], v5 offset:544
    v_mfma_f32_16x16x32_bf16 v[160:163], v[228:231], v[196:199], v[160:163]
    ds_read_b64_tr_b16 v[66:67], v5 offset:3360
    v_mfma_f32_16x16x32_bf16 v[164:167], v[232:235], v[192:195], v[164:167]
    ds_read_b64_tr_b16 v[68:69], v5 offset:576
    v_mfma_f32_16x16x32_bf16 v[168:171], v[232:235], v[196:199], v[168:171]
    ds_read_b64_tr_b16 v[70:71], v5 offset:3392
    v_mfma_f32_16x16x32_bf16 v[172:175], v[236:239], v[192:195], v[172:175]
    ds_read_b64_tr_b16 v[72:73], v5 offset:608
    v_mfma_f32_16x16x32_bf16 v[176:179], v[236:239], v[196:199], v[176:179]
    ds_read_b64_tr_b16 v[74:75], v5 offset:3424
    s_waitcnt lgkmcnt(0)
    s_barrier
    s_add_u32 s52, s52, 1
    s_cmp_lt_u32 s52, 7
    s_cbranch_scc1 k1_loop0
    s_nop 7
    s_nop 1
    v_and_b32 v6, 15, v1
    v_lshrrev_b32 v7, 4, v1
    s_lshl_b32 s46, s3, 7
    s_lshl_b32 s47, s49, 5
    s_add_u32 s46, s46, s47
    v_add_u32 v8, s46, v6
    v_mul_u32_u24 v90, 3584, v8
    v_lshlrev_b32 v9, 3, v7
    v_add_u32 v90, v90, v9
    s_mul_i32 s47, s2, 224
    v_add_u32 v90, s47, v90
    v_add_u32 v91, 57344, v90
    v_mul_f32 v94, 0xbfb8aa3b, v100
    v_mul_f32 v95, 0xbfb8aa3b, v101
    v_mul_f32 v96, 0xbfb8aa3b, v102
    v_mul_f32 v97, 0xbfb8aa3b, v103
    v_exp_f32 v94, v94
    v_exp_f32 v95, v95
    v_exp_f32 v96, v96
    v_exp_f32 v97, v97
    v_add_f32 v94, 1.0, v94
    v_add_f32 v95, 1.0, v95
    v_add_f32 v96, 1.0, v96
    v_add_f32 v97, 1.0, v97
    v_rcp_f32 v94, v94
    v_rcp_f32 v95, v95
    v_rcp_f32 v96, v96
    v_rcp_f32 v97, v97
    v_mul_f32 v94, v94, v100
    v_mul_f32 v95, v95, v101
    v_mul_f32 v96, v96, v102
    v_mul_f32 v97, v97, v103
    v_mul_f32 v100, v94, v140
    v_mul_f32 v101, v95, v141
    v_mul_f32 v102, v96, v142
    v_mul_f32 v103, v97, v143
    v_cvt_pk_bf16_f32 v100, v100, v101
    v_cvt_pk_bf16_f32 v101, v102, v103
    buffer_store_dwordx2 v[100:101], v90, s[32:35], 0 offen offset:64
    v_mul_f32 v94, 0xbfb8aa3b, v104
    v_mul_f32 v95, 0xbfb8aa3b, v105
    v_mul_f32 v96, 0xbfb8aa3b, v106
    v_mul_f32 v97, 0xbfb8aa3b, v107
    v_exp_f32 v94, v94
    v_exp_f32 v95, v95
    v_exp_f32 v96, v96
    v_exp_f32 v97, v97
    v_add_f32 v94, 1.0, v94
    v_add_f32 v95, 1.0, v95
    v_add_f32 v96, 1.0, v96
    v_add_f32 v97, 1.0, v97
    v_rcp_f32 v94, v94
    v_rcp_f32 v95, v95
    v_rcp_f32 v96, v96
    v_rcp_f32 v97, v97
    v_mul_f32 v94, v94, v104
    v_mul_f32 v95, v95, v105
    v_mul_f32 v96, v96, v106
    v_mul_f32 v97, v97, v107
    v_mul_f32 v104, v94, v144
    v_mul_f32 v105, v95, v145
    v_mul_f32 v106, v96, v146
    v_mul_f32 v107, v97, v147
    v_cvt_pk_bf16_f32 v104, v104, v105
    v_cvt_pk_bf16_f32 v105, v106, v107
    buffer_store_dwordx2 v[104:105], v91, s[32:35], 0 offen offset:64
    v_mul_f32 v94, 0xbfb8aa3b, v108
    v_mul_f32 v95, 0xbfb8aa3b, v109
    v_mul_f32 v96, 0xbfb8aa3b, v110
    v_mul_f32 v97, 0xbfb8aa3b, v111
    v_exp_f32 v94, v94
    v_exp_f32 v95, v95
    v_exp_f32 v96, v96
    v_exp_f32 v97, v97
    v_add_f32 v94, 1.0, v94
    v_add_f32 v95, 1.0, v95
    v_add_f32 v96, 1.0, v96
    v_add_f32 v97, 1.0, v97
    v_rcp_f32 v94, v94
    v_rcp_f32 v95, v95
    v_rcp_f32 v96, v96
    v_rcp_f32 v97, v97
    v_mul_f32 v94, v94, v108
    v_mul_f32 v95, v95, v109
    v_mul_f32 v96, v96, v110
    v_mul_f32 v97, v97, v111
    v_mul_f32 v108, v94, v148
    v_mul_f32 v109, v95, v149
    v_mul_f32 v110, v96, v150
    v_mul_f32 v111, v97, v151
    v_cvt_pk_bf16_f32 v108, v108, v109
    v_cvt_pk_bf16_f32 v109, v110, v111
    buffer_store_dwordx2 v[108:109], v90, s[32:35], 0 offen offset:96
    v_mul_f32 v94, 0xbfb8aa3b, v112
    v_mul_f32 v95, 0xbfb8aa3b, v113
    v_mul_f32 v96, 0xbfb8aa3b, v114
    v_mul_f32 v97, 0xbfb8aa3b, v115
    v_exp_f32 v94, v94
    v_exp_f32 v95, v95
    v_exp_f32 v96, v96
    v_exp_f32 v97, v97
    v_add_f32 v94, 1.0, v94
    v_add_f32 v95, 1.0, v95
    v_add_f32 v96, 1.0, v96
    v_add_f32 v97, 1.0, v97
    v_rcp_f32 v94, v94
    v_rcp_f32 v95, v95
    v_rcp_f32 v96, v96
    v_rcp_f32 v97, v97
    v_mul_f32 v94, v94, v112
    v_mul_f32 v95, v95, v113
    v_mul_f32 v96, v96, v114
    v_mul_f32 v97, v97, v115
    v_mul_f32 v112, v94, v152
    v_mul_f32 v113, v95, v153
    v_mul_f32 v114, v96, v154
    v_mul_f32 v115, v97, v155
    v_cvt_pk_bf16_f32 v112, v112, v113
    v_cvt_pk_bf16_f32 v113, v114, v115
    buffer_store_dwordx2 v[112:113], v91, s[32:35], 0 offen offset:96
    v_mul_f32 v94, 0xbfb8aa3b, v116
    v_mul_f32 v95, 0xbfb8aa3b, v117
    v_mul_f32 v96, 0xbfb8aa3b, v118
    v_mul_f32 v97, 0xbfb8aa3b, v119
    v_exp_f32 v94, v94
    v_exp_f32 v95, v95
    v_exp_f32 v96, v96
    v_exp_f32 v97, v97
    v_add_f32 v94, 1.0, v94
    v_add_f32 v95, 1.0, v95
    v_add_f32 v96, 1.0, v96
    v_add_f32 v97, 1.0, v97
    v_rcp_f32 v94, v94
    v_rcp_f32 v95, v95
    v_rcp_f32 v96, v96
    v_rcp_f32 v97, v97
    v_mul_f32 v94, v94, v116
    v_mul_f32 v95, v95, v117
    v_mul_f32 v96, v96, v118
    v_mul_f32 v97, v97, v119
    v_mul_f32 v116, v94, v156
    v_mul_f32 v117, v95, v157
    v_mul_f32 v118, v96, v158
    v_mul_f32 v119, v97, v159
    v_cvt_pk_bf16_f32 v116, v116, v117
    v_cvt_pk_bf16_f32 v117, v118, v119
    buffer_store_dwordx2 v[116:117], v90, s[32:35], 0 offen offset:128
    v_mul_f32 v94, 0xbfb8aa3b, v120
    v_mul_f32 v95, 0xbfb8aa3b, v121
    v_mul_f32 v96, 0xbfb8aa3b, v122
    v_mul_f32 v97, 0xbfb8aa3b, v123
    v_exp_f32 v94, v94
    v_exp_f32 v95, v95
    v_exp_f32 v96, v96
    v_exp_f32 v97, v97
    v_add_f32 v94, 1.0, v94
    v_add_f32 v95, 1.0, v95
    v_add_f32 v96, 1.0, v96
    v_add_f32 v97, 1.0, v97
    v_rcp_f32 v94, v94
    v_rcp_f32 v95, v95
    v_rcp_f32 v96, v96
    v_rcp_f32 v97, v97
    v_mul_f32 v94, v94, v120
    v_mul_f32 v95, v95, v121
    v_mul_f32 v96, v96, v122
    v_mul_f32 v97, v97, v123
    v_mul_f32 v120, v94, v160
    v_mul_f32 v121, v95, v161
    v_mul_f32 v122, v96, v162
    v_mul_f32 v123, v97, v163
    v_cvt_pk_bf16_f32 v120, v120, v121
    v_cvt_pk_bf16_f32 v121, v122, v123
    buffer_store_dwordx2 v[120:121], v91, s[32:35], 0 offen offset:128
    v_mul_f32 v94, 0xbfb8aa3b, v124
    v_mul_f32 v95, 0xbfb8aa3b, v125
    v_mul_f32 v96, 0xbfb8aa3b, v126
    v_mul_f32 v97, 0xbfb8aa3b, v127
    v_exp_f32 v94, v94
    v_exp_f32 v95, v95
    v_exp_f32 v96, v96
    v_exp_f32 v97, v97
    v_add_f32 v94, 1.0, v94
    v_add_f32 v95, 1.0, v95
    v_add_f32 v96, 1.0, v96
    v_add_f32 v97, 1.0, v97
    v_rcp_f32 v94, v94
    v_rcp_f32 v95, v95
    v_rcp_f32 v96, v96
    v_rcp_f32 v97, v97
    v_mul_f32 v94, v94, v124
    v_mul_f32 v95, v95, v125
    v_mul_f32 v96, v96, v126
    v_mul_f32 v97, v97, v127
    v_mul_f32 v124, v94, v164
    v_mul_f32 v125, v95, v165
    v_mul_f32 v126, v96, v166
    v_mul_f32 v127, v97, v167
    v_cvt_pk_bf16_f32 v124, v124, v125
    v_cvt_pk_bf16_f32 v125, v126, v127
    buffer_store_dwordx2 v[124:125], v90, s[32:35], 0 offen offset:160
    v_mul_f32 v94, 0xbfb8aa3b, v128
    v_mul_f32 v95, 0xbfb8aa3b, v129
    v_mul_f32 v96, 0xbfb8aa3b, v130
    v_mul_f32 v97, 0xbfb8aa3b, v131
    v_exp_f32 v94, v94
    v_exp_f32 v95, v95
    v_exp_f32 v96, v96
    v_exp_f32 v97, v97
    v_add_f32 v94, 1.0, v94
    v_add_f32 v95, 1.0, v95
    v_add_f32 v96, 1.0, v96
    v_add_f32 v97, 1.0, v97
    v_rcp_f32 v94, v94
    v_rcp_f32 v95, v95
    v_rcp_f32 v96, v96
    v_rcp_f32 v97, v97
    v_mul_f32 v94, v94, v128
    v_mul_f32 v95, v95, v129
    v_mul_f32 v96, v96, v130
    v_mul_f32 v97, v97, v131
    v_mul_f32 v128, v94, v168
    v_mul_f32 v129, v95, v169
    v_mul_f32 v130, v96, v170
    v_mul_f32 v131, v97, v171
    v_cvt_pk_bf16_f32 v128, v128, v129
    v_cvt_pk_bf16_f32 v129, v130, v131
    buffer_store_dwordx2 v[128:129], v91, s[32:35], 0 offen offset:160
    v_mul_f32 v94, 0xbfb8aa3b, v132
    v_mul_f32 v95, 0xbfb8aa3b, v133
    v_mul_f32 v96, 0xbfb8aa3b, v134
    v_mul_f32 v97, 0xbfb8aa3b, v135
    v_exp_f32 v94, v94
    v_exp_f32 v95, v95
    v_exp_f32 v96, v96
    v_exp_f32 v97, v97
    v_add_f32 v94, 1.0, v94
    v_add_f32 v95, 1.0, v95
    v_add_f32 v96, 1.0, v96
    v_add_f32 v97, 1.0, v97
    v_rcp_f32 v94, v94
    v_rcp_f32 v95, v95
    v_rcp_f32 v96, v96
    v_rcp_f32 v97, v97
    v_mul_f32 v94, v94, v132
    v_mul_f32 v95, v95, v133
    v_mul_f32 v96, v96, v134
    v_mul_f32 v97, v97, v135
    v_mul_f32 v132, v94, v172
    v_mul_f32 v133, v95, v173
    v_mul_f32 v134, v96, v174
    v_mul_f32 v135, v97, v175
    v_cvt_pk_bf16_f32 v132, v132, v133
    v_cvt_pk_bf16_f32 v133, v134, v135
    buffer_store_dwordx2 v[132:133], v90, s[32:35], 0 offen offset:192
    v_mul_f32 v94, 0xbfb8aa3b, v136
    v_mul_f32 v95, 0xbfb8aa3b, v137
    v_mul_f32 v96, 0xbfb8aa3b, v138
    v_mul_f32 v97, 0xbfb8aa3b, v139
    v_exp_f32 v94, v94
    v_exp_f32 v95, v95
    v_exp_f32 v96, v96
    v_exp_f32 v97, v97
    v_add_f32 v94, 1.0, v94
    v_add_f32 v95, 1.0, v95
    v_add_f32 v96, 1.0, v96
    v_add_f32 v97, 1.0, v97
    v_rcp_f32 v94, v94
    v_rcp_f32 v95, v95
    v_rcp_f32 v96, v96
    v_rcp_f32 v97, v97
    v_mul_f32 v94, v94, v136
    v_mul_f32 v95, v95, v137
    v_mul_f32 v96, v96, v138
    v_mul_f32 v97, v97, v139
    v_mul_f32 v136, v94, v176
    v_mul_f32 v137, v95, v177
    v_mul_f32 v138, v96, v178
    v_mul_f32 v139, v97, v179
    v_cvt_pk_bf16_f32 v136, v136, v137
    v_cvt_pk_bf16_f32 v137, v138, v139
    buffer_store_dwordx2 v[136:137], v91, s[32:35], 0 offen offset:192
k1_red:
    s_waitcnt lgkmcnt(0)
    s_barrier
    s_cmp_ge_u32 s14, 4
    s_cbranch_scc1 k1_done
    v_lshlrev_b32 v7, 4, v0
    v_add_u32 v8, 118784, v7
    ds_read_b128 v[48:51], v8 offset:0
    ds_read_b128 v[52:55], v8 offset:4096
    ds_read_b128 v[56:59], v8 offset:8192
    ds_read_b128 v[60:63], v8 offset:12288
    s_waitcnt lgkmcnt(0)
    v_add_f32 v48, v48, v52
    v_add_f32 v56, v56, v60
    v_add_f32 v48, v48, v56
    v_add_f32 v49, v49, v53
    v_add_f32 v57, v57, v61
    v_add_f32 v49, v49, v57
    v_add_f32 v50, v50, v54
    v_add_f32 v58, v58, v62
    v_add_f32 v50, v50, v58
    v_add_f32 v51, v51, v55
    v_add_f32 v59, v59, v63
    v_add_f32 v51, v51, v59
    s_lshl_b32 s46, s3, 4
    s_add_u32 s46, s46, s2
    s_lshl_b32 s46, s46, 12
    s_add_u32 s46, s46, 10485760
    buffer_store_dwordx4 v[48:51], v7, s[32:35], s46 offen
    s_waitcnt vmcnt(0)
k1_done:
    s_endpgm
.globl k23_kernel
.p2align 8
.type k23_kernel,@function
k23_kernel:
    s_cmp_lt_u32 s2, 32
    s_cbranch_scc1 kr_kernel_body
    s_sub_u32 s2, s2, 32
    s_cmp_ge_u32 s2, 224
    s_cbranch_scc1 k23_done
    v_lshrrev_b32 v1, 6, v0
    s_nop 0
    v_readfirstlane_b32 s53, v1
    s_nop 3
    s_add_u32 s53, s53, s2
    s_load_dwordx2 s[4:5], s[0:1], 0
    s_load_dwordx2 s[6:7], s[0:1], 48
    s_load_dwordx2 s[8:9], s[0:1], 56
    s_load_dwordx2 s[12:13], s[0:1], 72
    s_and_b32 s3, s2, 7
    s_lshr_b32 s2, s2, 3
    s_mul_i32 s14, s2, 9363
    s_lshr_b32 s14, s14, 16
    s_mul_i32 s15, s14, 7
    s_sub_u32 s2, s2, s15
    s_lshl_b32 s14, s14, 3
    s_add_u32 s3, s3, s14
    v_lshrrev_b32 v1, 6, v0
    s_nop 0
    v_readfirstlane_b32 s14, v1
    v_and_b32 v1, 63, v0
    s_waitcnt lgkmcnt(0)
    s_mov_b32 s16, s4
    s_mov_b32 s17, s5
    s_mov_b32 s18, 1835008
    s_mov_b32 s19, 0x00020000
    s_mov_b32 s20, s6
    s_mov_b32 s21, s7
    s_mov_b32 s22, 1605632
    s_mov_b32 s23, 0x00020000
    s_mov_b32 s24, s8
    s_mov_b32 s25, s9
    s_mov_b32 s26, 1835008
    s_mov_b32 s27, 0x00020000
    s_mov_b32 s32, s12
    s_mov_b32 s33, s13
    s_mov_b32 s34, 268435456
    s_mov_b32 s35, 0x00020000
    s_add_u32 s28, s12, 12582912
    s_addc_u32 s29, s13, 0
    s_mov_b32 s30, 401408
    s_mov_b32 s31, 0x00020000
    v_lshrrev_b32 v6, 3, v0
    v_and_b32 v7, 7, v0
    v_lshlrev_b32 v7, 4, v7
    s_lshl_b32 s46, s3, 6
    v_add_u32 v8, s46, v6
    v_mul_u32_u24 v2, 3584, v8
    v_add_u32 v2, v2, v7
    v_mul_u32_u24 v3, 896, v6
    v_add_u32 v3, v3, v7
    s_lshl_b32 s47, s2, 7
    v_add_u32 v3, s47, v3
    v_mul_u32_u24 v4, 160, v6
    v_add_u32 v4, v4, v7
    v_and_b32 v8, 8, v6
    v_lshlrev_b32 v8, 2, v8
    v_mul_u32_u24 v5, 192, v6
    v_add_u32 v5, v5, v7
    v_add_u32 v5, v5, v8
    v_add_u32 v5, 10240, v5
    s_and_b32 s49, s14, 3
    s_lshr_b32 s50, s14, 2
    v_and_b32 v6, 15, v1
    v_lshrrev_b32 v7, 4, v1
    s_lshl_b32 s47, s49, 4
    v_add_u32 v8, s47, v6
    v_mul_u32_u24 v9, 160, v8
    v_lshlrev_b32 v10, 4, v7
    v_add_u32 v10, v9, v10
    v_mul_u32_u24 v9, 928, v8
    v_lshlrev_b32 v12, 4, v7
    v_add_u32 v12, v9, v12
    v_add_u32 v12, 90112, v12
    v_lshlrev_b32 v8, 3, v7
    v_lshrrev_b32 v9, 2, v6
    v_add_u32 v8, v8, v9
    v_mul_u32_u24 v9, 192, v8
    v_and_b32 v8, 8, v8
    v_lshlrev_b32 v8, 2, v8
    v_add_u32 v9, v9, v8
    v_and_b32 v8, 3, v6
    v_lshlrev_b32 v8, 3, v8
    v_add_u32 v9, v9, v8
    s_lshl_b32 s47, s50, 6
    v_add_u32 v9, s47, v9
    v_add_u32 v11, 10240, v9
    v_add_u32 v16, 45056, v4
    v_add_u32 v17, 45056, v5
    v_add_u32 v18, 45056, v10
    v_add_u32 v19, 45056, v11
    s_mov_b32 s44, 0
    s_mov_b32 s45, 0
    buffer_load_dwordx4 v[152:155], v2, s[32:35], s44 offen
    buffer_load_dwordx4 v[156:159], v3, s[20:23], s45 offen
    s_add_u32 s44, s44, 128
    s_add_u32 s45, s45, 57344
    buffer_load_dwordx4 v[160:163], v2, s[32:35], s44 offen
    buffer_load_dwordx4 v[164:167], v3, s[20:23], s45 offen
    s_add_u32 s44, s44, 128
    s_add_u32 s45, s45, 57344
    buffer_load_dwordx4 v[168:171], v2, s[32:35], s44 offen
    buffer_load_dwordx4 v[172:175], v3, s[20:23], s45 offen
    s_add_u32 s44, s44, 128
    s_add_u32 s45, s45, 57344
    buffer_load_dwordx4 v[176:179], v2, s[32:35], s44 offen
    buffer_load_dwordx4 v[180:183], v3, s[20:23], s45 offen
    v_mov_b32 v100, 0
    v_mov_b32 v101, 0
    v_mov_b32 v102, 0
    v_mov_b32 v103, 0
    v_mov_b32 v104, 0
    v_mov_b32 v105, 0
    v_mov_b32 v106, 0
    v_mov_b32 v107, 0
    v_mov_b32 v108, 0
    v_mov_b32 v109, 0
    v_mov_b32 v110, 0
    v_mov_b32 v111, 0
    v_mov_b32 v112, 0
    v_mov_b32 v113, 0
    v_mov_b32 v114, 0
    v_mov_b32 v115, 0
    s_waitcnt vmcnt(4)
    ds_write_b128 v4, v[152:155] offset:0
    ds_write_b128 v5, v[156:159] offset:0
    ds_write_b128 v4, v[160:163] offset:22528
    ds_write_b128 v5, v[164:167] offset:22528
    s_add_u32 s44, s44, 128
    s_add_u32 s45, s45, 57344
    buffer_load_dwordx4 v[152:155], v2, s[32:35], s44 offen
    buffer_load_dwordx4 v[156:159], v3, s[20:23], s45 offen
    s_add_u32 s44, s44, 128
    s_add_u32 s45, s45, 57344
    buffer_load_dwordx4 v[160:163], v2, s[32:35], s44 offen
    buffer_load_dwordx4 v[164:167], v3, s[20:23], s45 offen
    s_waitcnt vmcnt(4)
    ds_write_b128 v16, v[168:171] offset:0
    ds_write_b128 v17, v[172:175] offset:0
    ds_write_b128 v16, v[176:179] offset:22528
    ds_write_b128 v17, v[180:183] offset:22528
    s_add_u32 s44, s44, 128
    s_add_u32 s45, s45, 57344
    buffer_load_dwordx4 v[168:171], v2, s[32:35], s44 offen
    buffer_load_dwordx4 v[172:175], v3, s[20:23], s45 offen
    s_add_u32 s44, s44, 128
    s_add_u32 s45, s45, 57344
    buffer_load_dwordx4 v[176:179], v2, s[32:35], s44 offen
    buffer_load_dwordx4 v[180:183], v3, s[20:23], s45 offen
    s_waitcnt lgkmcnt(0)
    s_barrier
    ds_read_b128 v[40:43], v10 offset:0
    ds_read_b64_tr_b16 v[48:49], v11 offset:0
    ds_read_b64_tr_b16 v[50:51], v11 offset:768
    ds_read_b64_tr_b16 v[52:53], v11 offset:32
    ds_read_b64_tr_b16 v[54:55], v11 offset:800
    ds_read_b128 v[44:47], v10 offset:64
    ds_read_b64_tr_b16 v[56:57], v11 offset:6144
    ds_read_b64_tr_b16 v[58:59], v11 offset:6912
    ds_read_b64_tr_b16 v[60:61], v11 offset:6176
    ds_read_b64_tr_b16 v[62:63], v11 offset:6944
    ds_read_b128 v[64:67], v10 offset:22528
    ds_read_b64_tr_b16 v[72:73], v11 offset:22528
    ds_read_b64_tr_b16 v[74:75], v11 offset:23296
    ds_read_b64_tr_b16 v[76:77], v11 offset:22560
    ds_read_b64_tr_b16 v[78:79], v11 offset:23328
    ds_read_b128 v[68:71], v10 offset:22592
    ds_read_b64_tr_b16 v[80:81], v11 offset:28672
    ds_read_b64_tr_b16 v[82:83], v11 offset:29440
    ds_read_b64_tr_b16 v[84:85], v11 offset:28704
    ds_read_b64_tr_b16 v[86:87], v11 offset:29472
    s_waitcnt lgkmcnt(0)
    s_barrier
    s_mov_b32 s52, 0
k23_loop:
    s_waitcnt vmcnt(4)
    ds_write_b128 v4, v[152:155] offset:0
    ds_write_b128 v5, v[156:159] offset:0
    ds_write_b128 v4, v[160:163] offset:22528
    ds_write_b128 v5, v[164:167] offset:22528
    s_add_u32 s44, s44, 128
    s_add_u32 s45, s45, 57344
    buffer_load_dwordx4 v[152:155], v2, s[32:35], s44 offen
    buffer_load_dwordx4 v[156:159], v3, s[20:23], s45 offen
    s_add_u32 s44, s44, 128
    s_add_u32 s45, s45, 57344
    buffer_load_dwordx4 v[160:163], v2, s[32:35], s44 offen
    buffer_load_dwordx4 v[164:167], v3, s[20:23], s45 offen
    v_mfma_f32_16x16x32_bf16 v[100:103], v[48:51], v[40:43], v[100:103]
    ds_read_b128 v[184:187], v18 offset:0
    ds_read_b64_tr_b16 v[192:193], v19 offset:0
    ds_read_b64_tr_b16 v[194:195], v19 offset:768
    v_mfma_f32_16x16x32_bf16 v[104:107], v[52:55], v[40:43], v[104:107]
    ds_read_b64_tr_b16 v[196:197], v19 offset:32
    ds_read_b64_tr_b16 v[198:199], v19 offset:800
    ds_read_b128 v[188:191], v18 offset:64
    v_mfma_f32_16x16x32_bf16 v[100:103], v[56:59], v[44:47], v[100:103]
    ds_read_b64_tr_b16 v[200:201], v19 offset:6144
    ds_read_b64_tr_b16 v[202:203], v19 offset:6912
    ds_read_b64_tr_b16 v[204:205], v19 offset:6176
    v_mfma_f32_16x16x32_bf16 v[104:107], v[60:63], v[44:47], v[104:107]
    ds_read_b64_tr_b16 v[206:207], v19 offset:6944
    ds_read_b128 v[208:211], v18 offset:22528
    ds_read_b64_tr_b16 v[216:217], v19 offset:22528
    v_mfma_f32_16x16x32_bf16 v[100:103], v[72:75], v[64:67], v[100:103]
    ds_read_b64_tr_b16 v[218:219], v19 offset:23296
    ds_read_b64_tr_b16 v[220:221], v19 offset:22560
    ds_read_b64_tr_b16 v[222:223], v19 offset:23328
    v_mfma_f32_16x16x32_bf16 v[104:107], v[76:79], v[64:67], v[104:107]
    ds_read_b128 v[212:215], v18 offset:22592
    ds_read_b64_tr_b16 v[224:225], v19 offset:28672
    ds_read_b64_tr_b16 v[226:227], v19 offset:29440
    v_mfma_f32_16x16x32_bf16 v[100:103], v[80:83], v[68:71], v[100:103]
    ds_read_b64_tr_b16 v[228:229], v19 offset:28704
    ds_read_b64_tr_b16 v[230:231], v19 offset:29472
    v_mfma_f32_16x16x32_bf16 v[104:107], v[84:87], v[68:71], v[104:107]
    s_waitcnt lgkmcnt(0)
    s_barrier
    s_waitcnt vmcnt(4)
    ds_write_b128 v16, v[168:171] offset:0
    ds_write_b128 v17, v[172:175] offset:0
    ds_write_b128 v16, v[176:179] offset:22528
    ds_write_b128 v17, v[180:183] offset:22528
    s_add_u32 s44, s44, 128
    s_add_u32 s45, s45, 57344
    buffer_load_dwordx4 v[168:171], v2, s[32:35], s44 offen
    buffer_load_dwordx4 v[172:175], v3, s[20:23], s45 offen
    s_add_u32 s44, s44, 128
    s_add_u32 s45, s45, 57344
    buffer_load_dwordx4 v[176:179], v2, s[32:35], s44 offen
    buffer_load_dwordx4 v[180:183], v3, s[20:23], s45 offen
    v_mfma_f32_16x16x32_bf16 v[100:103], v[192:195], v[184:187], v[100:103]
    ds_read_b128 v[40:43], v10 offset:0
    ds_read_b64_tr_b16 v[48:49], v11 offset:0
    ds_read_b64_tr_b16 v[50:51], v11 offset:768
    v_mfma_f32_16x16x32_bf16 v[104:107], v[196:199], v[184:187], v[104:107]
    ds_read_b64_tr_b16 v[52:53], v11 offset:32
    ds_read_b64_tr_b16 v[54:55], v11 offset:800
    ds_read_b128 v[44:47], v10 offset:64
    v_mfma_f32_16x16x32_bf16 v[100:103], v[200:203], v[188:191], v[100:103]
    ds_read_b64_tr_b16 v[56:57], v11 offset:6144
    ds_read_b64_tr_b16 v[58:59], v11 offset:6912
    ds_read_b64_tr_b16 v[60:61], v11 offset:6176
    v_mfma_f32_16x16x32_bf16 v[104:107], v[204:207], v[188:191], v[104:107]
    ds_read_b64_tr_b16 v[62:63], v11 offset:6944
    ds_read_b128 v[64:67], v10 offset:22528
    ds_read_b64_tr_b16 v[72:73], v11 offset:22528
    v_mfma_f32_16x16x32_bf16 v[100:103], v[216:219], v[208:211], v[100:103]
    ds_read_b64_tr_b16 v[74:75], v11 offset:23296
    ds_read_b64_tr_b16 v[76:77], v11 offset:22560
    ds_read_b64_tr_b16 v[78:79], v11 offset:23328
    v_mfma_f32_16x16x32_bf16 v[104:107], v[220:223], v[208:211], v[104:107]
    ds_read_b128 v[68:71], v10 offset:22592
    ds_read_b64_tr_b16 v[80:81], v11 offset:28672
    ds_read_b64_tr_b16 v[82:83], v11 offset:29440
    v_mfma_f32_16x16x32_bf16 v[100:103], v[224:227], v[212:215], v[100:103]
    ds_read_b64_tr_b16 v[84:85], v11 offset:28704
    ds_read_b64_tr_b16 v[86:87], v11 offset:29472
    v_mfma_f32_16x16x32_bf16 v[104:107], v[228:231], v[212:215], v[104:107]
    s_waitcnt lgkmcnt(0)
    s_barrier
    s_add_u32 s52, s52, 1
    s_cmp_lt_u32 s52, 5
    s_cbranch_scc1 k23_loop
    s_load_dwordx2 s[56:57], s[0:1], 64
    s_waitcnt lgkmcnt(0)
    s_mov_b32 s58, 256
    s_mov_b32 s59, 0x00020000
    v_mov_b32 v34, 0
k23_poll:
    buffer_load_dword v35, v34, s[56:59], 0 offen sc1
    s_waitcnt vmcnt(0)
    v_readfirstlane_b32 s54, v35
    s_nop 3
    s_cmp_ge_u32 s54, 32
    s_cbranch_scc1 k23_go
    s_sleep 2
    s_branch k23_poll
k23_go:
    v_and_b32 v36, 15, v0
    v_mul_u32_u24 v37, 56, v36
    v_lshrrev_b32 v38, 4, v0
    v_lshlrev_b32 v34, 1, v37
    s_mov_b32 s51, 13631488
    buffer_load_dwordx4 v[116:119], v34, s[32:35], s51 offen offset:0 sc1
    buffer_load_dwordx4 v[120:123], v34, s[32:35], s51 offen offset:16 sc1
    buffer_load_dwordx4 v[124:127], v34, s[32:35], s51 offen offset:32 sc1
    buffer_load_dwordx4 v[128:131], v34, s[32:35], s51 offen offset:48 sc1
    buffer_load_dwordx4 v[132:135], v34, s[32:35], s51 offen offset:64 sc1
    buffer_load_dwordx4 v[136:139], v34, s[32:35], s51 offen offset:80 sc1
    buffer_load_dwordx4 v[140:143], v34, s[32:35], s51 offen offset:96 sc1
    s_mov_b32 s55, 8388608
    v_add_u32 v39, 0, v38
    v_add_u32 v34, s46, v39
    v_mul_u32_u24 v34, 896, v34
    v_add_u32 v34, v34, v37
    buffer_load_dwordx2 v[232:233], v34, s[32:35], s55 offen offset:0
    buffer_load_dwordx2 v[234:235], v34, s[32:35], s55 offen offset:8
    buffer_load_dwordx2 v[236:237], v34, s[32:35], s55 offen offset:16
    buffer_load_dwordx2 v[238:239], v34, s[32:35], s55 offen offset:24
    buffer_load_dwordx2 v[240:241], v34, s[32:35], s55 offen offset:32
    buffer_load_dwordx2 v[242:243], v34, s[32:35], s55 offen offset:40
    buffer_load_dwordx2 v[244:245], v34, s[32:35], s55 offen offset:48
    v_add_u32 v39, 32, v38
    v_add_u32 v34, s46, v39
    v_mul_u32_u24 v34, 896, v34
    v_add_u32 v34, v34, v37
    buffer_load_dwordx2 v[20:21], v34, s[32:35], s55 offen offset:0
    buffer_load_dwordx2 v[22:23], v34, s[32:35], s55 offen offset:8
    buffer_load_dwordx2 v[24:25], v34, s[32:35], s55 offen offset:16
    buffer_load_dwordx2 v[26:27], v34, s[32:35], s55 offen offset:24
    buffer_load_dwordx2 v[28:29], v34, s[32:35], s55 offen offset:32
    buffer_load_dwordx2 v[30:31], v34, s[32:35], s55 offen offset:40
    buffer_load_dwordx2 v[32:33], v34, s[32:35], s55 offen offset:48
    s_waitcnt vmcnt(0)
    v_mov_b32 v88, 0x358637bd
    v_mov_b32 v89, 0
    v_lshlrev_b32 v90, 16, v232
    v_and_b32 v91, 0xffff0000, v232
    v_fmac_f32 v88, v90, v116
    v_fmac_f32 v89, v91, v117
    v_lshlrev_b32 v90, 16, v233
    v_and_b32 v91, 0xffff0000, v233
    v_fmac_f32 v88, v90, v118
    v_fmac_f32 v89, v91, v119
    v_lshlrev_b32 v90, 16, v234
    v_and_b32 v91, 0xffff0000, v234
    v_fmac_f32 v88, v90, v120
    v_fmac_f32 v89, v91, v121
    v_lshlrev_b32 v90, 16, v235
    v_and_b32 v91, 0xffff0000, v235
    v_fmac_f32 v88, v90, v122
    v_fmac_f32 v89, v91, v123
    v_lshlrev_b32 v90, 16, v236
    v_and_b32 v91, 0xffff0000, v236
    v_fmac_f32 v88, v90, v124
    v_fmac_f32 v89, v91, v125
    v_lshlrev_b32 v90, 16, v237
    v_and_b32 v91, 0xffff0000, v237
    v_fmac_f32 v88, v90, v126
    v_fmac_f32 v89, v91, v127
    v_lshlrev_b32 v90, 16, v238
    v_and_b32 v91, 0xffff0000, v238
    v_fmac_f32 v88, v90, v128
    v_fmac_f32 v89, v91, v129
    v_lshlrev_b32 v90, 16, v239
    v_and_b32 v91, 0xffff0000, v239
    v_fmac_f32 v88, v90, v130
    v_fmac_f32 v89, v91, v131
    v_lshlrev_b32 v90, 16, v240
    v_and_b32 v91, 0xffff0000, v240
    v_fmac_f32 v88, v90, v132
    v_fmac_f32 v89, v91, v133
    v_lshlrev_b32 v90, 16, v241
    v_and_b32 v91, 0xffff0000, v241
    v_fmac_f32 v88, v90, v134
    v_fmac_f32 v89, v91, v135
    v_lshlrev_b32 v90, 16, v242
    v_and_b32 v91, 0xffff0000, v242
    v_fmac_f32 v88, v90, v136
    v_fmac_f32 v89, v91, v137
    v_lshlrev_b32 v90, 16, v243
    v_and_b32 v91, 0xffff0000, v243
    v_fmac_f32 v88, v90, v138
    v_fmac_f32 v89, v91, v139
    v_lshlrev_b32 v90, 16, v244
    v_and_b32 v91, 0xffff0000, v244
    v_fmac_f32 v88, v90, v140
    v_fmac_f32 v89, v91, v141
    v_lshlrev_b32 v90, 16, v245
    v_and_b32 v91, 0xffff0000, v245
    v_fmac_f32 v88, v90, v142
    v_fmac_f32 v89, v91, v143
    v_add_f32 v88, v88, v89
    v_rcp_f32 v88, v88
    s_nop 0
    v_lshlrev_b32 v90, 16, v232
    v_and_b32 v91, 0xffff0000, v232
    v_mul_f32 v90, v90, v88
    v_mul_f32 v91, v91, v88
    v_cvt_pk_bf16_f32 v232, v90, v91
    v_lshlrev_b32 v90, 16, v233
    v_and_b32 v91, 0xffff0000, v233
    v_mul_f32 v90, v90, v88
    v_mul_f32 v91, v91, v88
    v_cvt_pk_bf16_f32 v233, v90, v91
    v_lshlrev_b32 v90, 16, v234
    v_and_b32 v91, 0xffff0000, v234
    v_mul_f32 v90, v90, v88
    v_mul_f32 v91, v91, v88
    v_cvt_pk_bf16_f32 v234, v90, v91
    v_lshlrev_b32 v90, 16, v235
    v_and_b32 v91, 0xffff0000, v235
    v_mul_f32 v90, v90, v88
    v_mul_f32 v91, v91, v88
    v_cvt_pk_bf16_f32 v235, v90, v91
    v_lshlrev_b32 v90, 16, v236
    v_and_b32 v91, 0xffff0000, v236
    v_mul_f32 v90, v90, v88
    v_mul_f32 v91, v91, v88
    v_cvt_pk_bf16_f32 v236, v90, v91
    v_lshlrev_b32 v90, 16, v237
    v_and_b32 v91, 0xffff0000, v237
    v_mul_f32 v90, v90, v88
    v_mul_f32 v91, v91, v88
    v_cvt_pk_bf16_f32 v237, v90, v91
    v_lshlrev_b32 v90, 16, v238
    v_and_b32 v91, 0xffff0000, v238
    v_mul_f32 v90, v90, v88
    v_mul_f32 v91, v91, v88
    v_cvt_pk_bf16_f32 v238, v90, v91
    v_lshlrev_b32 v90, 16, v239
    v_and_b32 v91, 0xffff0000, v239
    v_mul_f32 v90, v90, v88
    v_mul_f32 v91, v91, v88
    v_cvt_pk_bf16_f32 v239, v90, v91
    v_lshlrev_b32 v90, 16, v240
    v_and_b32 v91, 0xffff0000, v240
    v_mul_f32 v90, v90, v88
    v_mul_f32 v91, v91, v88
    v_cvt_pk_bf16_f32 v240, v90, v91
    v_lshlrev_b32 v90, 16, v241
    v_and_b32 v91, 0xffff0000, v241
    v_mul_f32 v90, v90, v88
    v_mul_f32 v91, v91, v88
    v_cvt_pk_bf16_f32 v241, v90, v91
    v_lshlrev_b32 v90, 16, v242
    v_and_b32 v91, 0xffff0000, v242
    v_mul_f32 v90, v90, v88
    v_mul_f32 v91, v91, v88
    v_cvt_pk_bf16_f32 v242, v90, v91
    v_lshlrev_b32 v90, 16, v243
    v_and_b32 v91, 0xffff0000, v243
    v_mul_f32 v90, v90, v88
    v_mul_f32 v91, v91, v88
    v_cvt_pk_bf16_f32 v243, v90, v91
    v_lshlrev_b32 v90, 16, v244
    v_and_b32 v91, 0xffff0000, v244
    v_mul_f32 v90, v90, v88
    v_mul_f32 v91, v91, v88
    v_cvt_pk_bf16_f32 v244, v90, v91
    v_lshlrev_b32 v90, 16, v245
    v_and_b32 v91, 0xffff0000, v245
    v_mul_f32 v90, v90, v88
    v_mul_f32 v91, v91, v88
    v_cvt_pk_bf16_f32 v245, v90, v91
    v_add_u32 v39, 0, v38
    v_mul_u32_u24 v34, 928, v39
    v_add_u32 v34, v34, v37
    v_add_u32 v34, 90112, v34
    ds_write_b64 v34, v[232:233] offset:0
    ds_write_b64 v34, v[234:235] offset:8
    ds_write_b64 v34, v[236:237] offset:16
    ds_write_b64 v34, v[238:239] offset:24
    ds_write_b64 v34, v[240:241] offset:32
    ds_write_b64 v34, v[242:243] offset:40
    ds_write_b64 v34, v[244:245] offset:48
    v_mov_b32 v88, 0x358637bd
    v_mov_b32 v89, 0
    v_lshlrev_b32 v90, 16, v20
    v_and_b32 v91, 0xffff0000, v20
    v_fmac_f32 v88, v90, v116
    v_fmac_f32 v89, v91, v117
    v_lshlrev_b32 v90, 16, v21
    v_and_b32 v91, 0xffff0000, v21
    v_fmac_f32 v88, v90, v118
    v_fmac_f32 v89, v91, v119
    v_lshlrev_b32 v90, 16, v22
    v_and_b32 v91, 0xffff0000, v22
    v_fmac_f32 v88, v90, v120
    v_fmac_f32 v89, v91, v121
    v_lshlrev_b32 v90, 16, v23
    v_and_b32 v91, 0xffff0000, v23
    v_fmac_f32 v88, v90, v122
    v_fmac_f32 v89, v91, v123
    v_lshlrev_b32 v90, 16, v24
    v_and_b32 v91, 0xffff0000, v24
    v_fmac_f32 v88, v90, v124
    v_fmac_f32 v89, v91, v125
    v_lshlrev_b32 v90, 16, v25
    v_and_b32 v91, 0xffff0000, v25
    v_fmac_f32 v88, v90, v126
    v_fmac_f32 v89, v91, v127
    v_lshlrev_b32 v90, 16, v26
    v_and_b32 v91, 0xffff0000, v26
    v_fmac_f32 v88, v90, v128
    v_fmac_f32 v89, v91, v129
    v_lshlrev_b32 v90, 16, v27
    v_and_b32 v91, 0xffff0000, v27
    v_fmac_f32 v88, v90, v130
    v_fmac_f32 v89, v91, v131
    v_lshlrev_b32 v90, 16, v28
    v_and_b32 v91, 0xffff0000, v28
    v_fmac_f32 v88, v90, v132
    v_fmac_f32 v89, v91, v133
    v_lshlrev_b32 v90, 16, v29
    v_and_b32 v91, 0xffff0000, v29
    v_fmac_f32 v88, v90, v134
    v_fmac_f32 v89, v91, v135
    v_lshlrev_b32 v90, 16, v30
    v_and_b32 v91, 0xffff0000, v30
    v_fmac_f32 v88, v90, v136
    v_fmac_f32 v89, v91, v137
    v_lshlrev_b32 v90, 16, v31
    v_and_b32 v91, 0xffff0000, v31
    v_fmac_f32 v88, v90, v138
    v_fmac_f32 v89, v91, v139
    v_lshlrev_b32 v90, 16, v32
    v_and_b32 v91, 0xffff0000, v32
    v_fmac_f32 v88, v90, v140
    v_fmac_f32 v89, v91, v141
    v_lshlrev_b32 v90, 16, v33
    v_and_b32 v91, 0xffff0000, v33
    v_fmac_f32 v88, v90, v142
    v_fmac_f32 v89, v91, v143
    v_add_f32 v88, v88, v89
    v_rcp_f32 v88, v88
    s_nop 0
    v_lshlrev_b32 v90, 16, v20
    v_and_b32 v91, 0xffff0000, v20
    v_mul_f32 v90, v90, v88
    v_mul_f32 v91, v91, v88
    v_cvt_pk_bf16_f32 v20, v90, v91
    v_lshlrev_b32 v90, 16, v21
    v_and_b32 v91, 0xffff0000, v21
    v_mul_f32 v90, v90, v88
    v_mul_f32 v91, v91, v88
    v_cvt_pk_bf16_f32 v21, v90, v91
    v_lshlrev_b32 v90, 16, v22
    v_and_b32 v91, 0xffff0000, v22
    v_mul_f32 v90, v90, v88
    v_mul_f32 v91, v91, v88
    v_cvt_pk_bf16_f32 v22, v90, v91
    v_lshlrev_b32 v90, 16, v23
    v_and_b32 v91, 0xffff0000, v23
    v_mul_f32 v90, v90, v88
    v_mul_f32 v91, v91, v88
    v_cvt_pk_bf16_f32 v23, v90, v91
    v_lshlrev_b32 v90, 16, v24
    v_and_b32 v91, 0xffff0000, v24
    v_mul_f32 v90, v90, v88
    v_mul_f32 v91, v91, v88
    v_cvt_pk_bf16_f32 v24, v90, v91
    v_lshlrev_b32 v90, 16, v25
    v_and_b32 v91, 0xffff0000, v25
    v_mul_f32 v90, v90, v88
    v_mul_f32 v91, v91, v88
    v_cvt_pk_bf16_f32 v25, v90, v91
    v_lshlrev_b32 v90, 16, v26
    v_and_b32 v91, 0xffff0000, v26
    v_mul_f32 v90, v90, v88
    v_mul_f32 v91, v91, v88
    v_cvt_pk_bf16_f32 v26, v90, v91
    v_lshlrev_b32 v90, 16, v27
    v_and_b32 v91, 0xffff0000, v27
    v_mul_f32 v90, v90, v88
    v_mul_f32 v91, v91, v88
    v_cvt_pk_bf16_f32 v27, v90, v91
    v_lshlrev_b32 v90, 16, v28
    v_and_b32 v91, 0xffff0000, v28
    v_mul_f32 v90, v90, v88
    v_mul_f32 v91, v91, v88
    v_cvt_pk_bf16_f32 v28, v90, v91
    v_lshlrev_b32 v90, 16, v29
    v_and_b32 v91, 0xffff0000, v29
    v_mul_f32 v90, v90, v88
    v_mul_f32 v91, v91, v88
    v_cvt_pk_bf16_f32 v29, v90, v91
    v_lshlrev_b32 v90, 16, v30
    v_and_b32 v91, 0xffff0000, v30
    v_mul_f32 v90, v90, v88
    v_mul_f32 v91, v91, v88
    v_cvt_pk_bf16_f32 v30, v90, v91
    v_lshlrev_b32 v90, 16, v31
    v_and_b32 v91, 0xffff0000, v31
    v_mul_f32 v90, v90, v88
    v_mul_f32 v91, v91, v88
    v_cvt_pk_bf16_f32 v31, v90, v91
    v_lshlrev_b32 v90, 16, v32
    v_and_b32 v91, 0xffff0000, v32
    v_mul_f32 v90, v90, v88
    v_mul_f32 v91, v91, v88
    v_cvt_pk_bf16_f32 v32, v90, v91
    v_lshlrev_b32 v90, 16, v33
    v_and_b32 v91, 0xffff0000, v33
    v_mul_f32 v90, v90, v88
    v_mul_f32 v91, v91, v88
    v_cvt_pk_bf16_f32 v33, v90, v91
    v_add_u32 v39, 32, v38
    v_mul_u32_u24 v34, 928, v39
    v_add_u32 v34, v34, v37
    v_add_u32 v34, 90112, v34
    ds_write_b64 v34, v[20:21] offset:0
    ds_write_b64 v34, v[22:23] offset:8
    ds_write_b64 v34, v[24:25] offset:16
    ds_write_b64 v34, v[26:27] offset:24
    ds_write_b64 v34, v[28:29] offset:32
    ds_write_b64 v34, v[30:31] offset:40
    ds_write_b64 v34, v[32:33] offset:48
    s_waitcnt vmcnt(4)
    ds_write_b128 v4, v[152:155] offset:0
    ds_write_b128 v5, v[156:159] offset:0
    ds_write_b128 v4, v[160:163] offset:22528
    ds_write_b128 v5, v[164:167] offset:22528
    s_mov_b32 s45, 0
    buffer_load_dwordx4 v[156:159], v3, s[28:31], s45 offen sc1
    s_mov_b32 s45, 57344
    buffer_load_dwordx4 v[164:167], v3, s[28:31], s45 offen sc1
    v_mfma_f32_16x16x32_bf16 v[100:103], v[48:51], v[40:43], v[100:103]
    ds_read_b128 v[184:187], v18 offset:0
    ds_read_b64_tr_b16 v[192:193], v19 offset:0
    ds_read_b64_tr_b16 v[194:195], v19 offset:768
    v_mfma_f32_16x16x32_bf16 v[104:107], v[52:55], v[40:43], v[104:107]
    ds_read_b64_tr_b16 v[196:197], v19 offset:32
    ds_read_b64_tr_b16 v[198:199], v19 offset:800
    ds_read_b128 v[188:191], v18 offset:64
    v_mfma_f32_16x16x32_bf16 v[100:103], v[56:59], v[44:47], v[100:103]
    ds_read_b64_tr_b16 v[200:201], v19 offset:6144
    ds_read_b64_tr_b16 v[202:203], v19 offset:6912
    ds_read_b64_tr_b16 v[204:205], v19 offset:6176
    v_mfma_f32_16x16x32_bf16 v[104:107], v[60:63], v[44:47], v[104:107]
    ds_read_b64_tr_b16 v[206:207], v19 offset:6944
    ds_read_b128 v[208:211], v18 offset:22528
    ds_read_b64_tr_b16 v[216:217], v19 offset:22528
    v_mfma_f32_16x16x32_bf16 v[100:103], v[72:75], v[64:67], v[100:103]
    ds_read_b64_tr_b16 v[218:219], v19 offset:23296
    ds_read_b64_tr_b16 v[220:221], v19 offset:22560
    ds_read_b64_tr_b16 v[222:223], v19 offset:23328
    v_mfma_f32_16x16x32_bf16 v[104:107], v[76:79], v[64:67], v[104:107]
    ds_read_b128 v[212:215], v18 offset:22592
    ds_read_b64_tr_b16 v[224:225], v19 offset:28672
    ds_read_b64_tr_b16 v[226:227], v19 offset:29440
    v_mfma_f32_16x16x32_bf16 v[100:103], v[80:83], v[68:71], v[100:103]
    ds_read_b64_tr_b16 v[228:229], v19 offset:28704
    ds_read_b64_tr_b16 v[230:231], v19 offset:29472
    v_mfma_f32_16x16x32_bf16 v[104:107], v[84:87], v[68:71], v[104:107]
    s_waitcnt lgkmcnt(0)
    s_barrier
    s_waitcnt vmcnt(2)
    ds_write_b128 v16, v[168:171] offset:0
    ds_write_b128 v17, v[172:175] offset:0
    ds_write_b128 v16, v[176:179] offset:22528
    ds_write_b128 v17, v[180:183] offset:22528
    s_mov_b32 s45, 114688
    buffer_load_dwordx4 v[172:175], v3, s[28:31], s45 offen sc1
    s_mov_b32 s45, 172032
    buffer_load_dwordx4 v[180:183], v3, s[28:31], s45 offen sc1
    v_mfma_f32_16x16x32_bf16 v[100:103], v[192:195], v[184:187], v[100:103]
    ds_read_b128 v[40:43], v10 offset:0
    ds_read_b64_tr_b16 v[48:49], v11 offset:0
    ds_read_b64_tr_b16 v[50:51], v11 offset:768
    v_mfma_f32_16x16x32_bf16 v[104:107], v[196:199], v[184:187], v[104:107]
    ds_read_b64_tr_b16 v[52:53], v11 offset:32
    ds_read_b64_tr_b16 v[54:55], v11 offset:800
    ds_read_b128 v[44:47], v10 offset:64
    v_mfma_f32_16x16x32_bf16 v[100:103], v[200:203], v[188:191], v[100:103]
    ds_read_b64_tr_b16 v[56:57], v11 offset:6144
    ds_read_b64_tr_b16 v[58:59], v11 offset:6912
    ds_read_b64_tr_b16 v[60:61], v11 offset:6176
    v_mfma_f32_16x16x32_bf16 v[104:107], v[204:207], v[188:191], v[104:107]
    ds_read_b64_tr_b16 v[62:63], v11 offset:6944
    ds_read_b128 v[64:67], v10 offset:22528
    ds_read_b64_tr_b16 v[72:73], v11 offset:22528
    v_mfma_f32_16x16x32_bf16 v[100:103], v[216:219], v[208:211], v[100:103]
    ds_read_b64_tr_b16 v[74:75], v11 offset:23296
    ds_read_b64_tr_b16 v[76:77], v11 offset:22560
    ds_read_b64_tr_b16 v[78:79], v11 offset:23328
    v_mfma_f32_16x16x32_bf16 v[104:107], v[220:223], v[208:211], v[104:107]
    ds_read_b128 v[68:71], v10 offset:22592
    ds_read_b64_tr_b16 v[80:81], v11 offset:28672
    ds_read_b64_tr_b16 v[82:83], v11 offset:29440
    v_mfma_f32_16x16x32_bf16 v[100:103], v[224:227], v[212:215], v[100:103]
    ds_read_b64_tr_b16 v[84:85], v11 offset:28704
    ds_read_b64_tr_b16 v[86:87], v11 offset:29472
    v_mfma_f32_16x16x32_bf16 v[104:107], v[228:231], v[212:215], v[104:107]
    s_waitcnt lgkmcnt(0)
    s_barrier
    s_waitcnt vmcnt(2)
    ds_write_b128 v5, v[156:159] offset:0
    ds_write_b128 v5, v[164:167] offset:22528
    s_mov_b32 s45, 229376
    buffer_load_dwordx4 v[156:159], v3, s[28:31], s45 offen sc1
    s_mov_b32 s45, 286720
    buffer_load_dwordx4 v[164:167], v3, s[28:31], s45 offen sc1
    v_mfma_f32_16x16x32_bf16 v[100:103], v[48:51], v[40:43], v[100:103]
    ds_read_b128 v[184:187], v18 offset:0
    ds_read_b64_tr_b16 v[192:193], v19 offset:0
    ds_read_b64_tr_b16 v[194:195], v19 offset:768
    v_mfma_f32_16x16x32_bf16 v[104:107], v[52:55], v[40:43], v[104:107]
    ds_read_b64_tr_b16 v[196:197], v19 offset:32
    ds_read_b64_tr_b16 v[198:199], v19 offset:800
    ds_read_b128 v[188:191], v18 offset:64
    v_mfma_f32_16x16x32_bf16 v[100:103], v[56:59], v[44:47], v[100:103]
    ds_read_b64_tr_b16 v[200:201], v19 offset:6144
    ds_read_b64_tr_b16 v[202:203], v19 offset:6912
    ds_read_b64_tr_b16 v[204:205], v19 offset:6176
    v_mfma_f32_16x16x32_bf16 v[104:107], v[60:63], v[44:47], v[104:107]
    ds_read_b64_tr_b16 v[206:207], v19 offset:6944
    ds_read_b128 v[208:211], v18 offset:22528
    ds_read_b64_tr_b16 v[216:217], v19 offset:22528
    v_mfma_f32_16x16x32_bf16 v[100:103], v[72:75], v[64:67], v[100:103]
    ds_read_b64_tr_b16 v[218:219], v19 offset:23296
    ds_read_b64_tr_b16 v[220:221], v19 offset:22560
    ds_read_b64_tr_b16 v[222:223], v19 offset:23328
    v_mfma_f32_16x16x32_bf16 v[104:107], v[76:79], v[64:67], v[104:107]
    ds_read_b128 v[212:215], v18 offset:22592
    ds_read_b64_tr_b16 v[224:225], v19 offset:28672
    ds_read_b64_tr_b16 v[226:227], v19 offset:29440
    v_mfma_f32_16x16x32_bf16 v[100:103], v[80:83], v[68:71], v[100:103]
    ds_read_b64_tr_b16 v[228:229], v19 offset:28704
    ds_read_b64_tr_b16 v[230:231], v19 offset:29472
    v_mfma_f32_16x16x32_bf16 v[104:107], v[84:87], v[68:71], v[104:107]
    s_waitcnt lgkmcnt(0)
    s_barrier
    s_waitcnt vmcnt(2)
    ds_write_b128 v17, v[172:175] offset:0
    ds_write_b128 v17, v[180:183] offset:22528
    s_mov_b32 s45, 344064
    buffer_load_dwordx4 v[172:175], v3, s[28:31], s45 offen sc1
    v_mfma_f32_16x16x32_bf16 v[100:103], v[192:195], v[184:187], v[100:103]
    ds_read_b128 v[40:43], v12 offset:0
    ds_read_b64_tr_b16 v[48:49], v11 offset:0
    ds_read_b64_tr_b16 v[50:51], v11 offset:768
    v_mfma_f32_16x16x32_bf16 v[104:107], v[196:199], v[184:187], v[104:107]
    ds_read_b64_tr_b16 v[52:53], v11 offset:32
    ds_read_b64_tr_b16 v[54:55], v11 offset:800
    ds_read_b128 v[44:47], v12 offset:64
    v_mfma_f32_16x16x32_bf16 v[100:103], v[200:203], v[188:191], v[100:103]
    ds_read_b64_tr_b16 v[56:57], v11 offset:6144
    ds_read_b64_tr_b16 v[58:59], v11 offset:6912
    ds_read_b64_tr_b16 v[60:61], v11 offset:6176
    v_mfma_f32_16x16x32_bf16 v[104:107], v[204:207], v[188:191], v[104:107]
    ds_read_b64_tr_b16 v[62:63], v11 offset:6944
    ds_read_b128 v[64:67], v12 offset:128
    ds_read_b64_tr_b16 v[72:73], v11 offset:22528
    v_mfma_f32_16x16x32_bf16 v[100:103], v[216:219], v[208:211], v[100:103]
    ds_read_b64_tr_b16 v[74:75], v11 offset:23296
    ds_read_b64_tr_b16 v[76:77], v11 offset:22560
    ds_read_b64_tr_b16 v[78:79], v11 offset:23328
    v_mfma_f32_16x16x32_bf16 v[104:107], v[220:223], v[208:211], v[104:107]
    ds_read_b128 v[68:71], v12 offset:192
    ds_read_b64_tr_b16 v[80:81], v11 offset:28672
    ds_read_b64_tr_b16 v[82:83], v11 offset:29440
    v_mfma_f32_16x16x32_bf16 v[100:103], v[224:227], v[212:215], v[100:103]
    ds_read_b64_tr_b16 v[84:85], v11 offset:28704
    ds_read_b64_tr_b16 v[86:87], v11 offset:29472
    v_mfma_f32_16x16x32_bf16 v[104:107], v[228:231], v[212:215], v[104:107]
    s_waitcnt lgkmcnt(0)
    s_barrier
    s_waitcnt vmcnt(1)
    ds_write_b128 v5, v[156:159] offset:0
    ds_write_b128 v5, v[164:167] offset:22528
    v_mfma_f32_16x16x32_bf16 v[108:111], v[48:51], v[40:43], v[108:111]
    ds_read_b128 v[184:187], v12 offset:256
    ds_read_b64_tr_b16 v[192:193], v19 offset:0
    ds_read_b64_tr_b16 v[194:195], v19 offset:768
    v_mfma_f32_16x16x32_bf16 v[112:115], v[52:55], v[40:43], v[112:115]
    ds_read_b64_tr_b16 v[196:197], v19 offset:32
    ds_read_b64_tr_b16 v[198:199], v19 offset:800
    ds_read_b128 v[188:191], v12 offset:320
    v_mfma_f32_16x16x32_bf16 v[108:111], v[56:59], v[44:47], v[108:111]
    ds_read_b64_tr_b16 v[200:201], v19 offset:6144
    ds_read_b64_tr_b16 v[202:203], v19 offset:6912
    ds_read_b64_tr_b16 v[204:205], v19 offset:6176
    v_mfma_f32_16x16x32_bf16 v[112:115], v[60:63], v[44:47], v[112:115]
    ds_read_b64_tr_b16 v[206:207], v19 offset:6944
    ds_read_b128 v[208:211], v12 offset:384
    ds_read_b64_tr_b16 v[216:217], v19 offset:22528
    v_mfma_f32_16x16x32_bf16 v[108:111], v[72:75], v[64:67], v[108:111]
    ds_read_b64_tr_b16 v[218:219], v19 offset:23296
    ds_read_b64_tr_b16 v[220:221], v19 offset:22560
    ds_read_b64_tr_b16 v[222:223], v19 offset:23328
    v_mfma_f32_16x16x32_bf16 v[112:115], v[76:79], v[64:67], v[112:115]
    ds_read_b128 v[212:215], v12 offset:448
    ds_read_b64_tr_b16 v[224:225], v19 offset:28672
    ds_read_b64_tr_b16 v[226:227], v19 offset:29440
    v_mfma_f32_16x16x32_bf16 v[108:111], v[80:83], v[68:71], v[108:111]
    ds_read_b64_tr_b16 v[228:229], v19 offset:28704
    ds_read_b64_tr_b16 v[230:231], v19 offset:29472
    v_mfma_f32_16x16x32_bf16 v[112:115], v[84:87], v[68:71], v[112:115]
    s_waitcnt lgkmcnt(0)
    s_barrier
    s_waitcnt vmcnt(0)
    ds_write_b128 v17, v[172:175] offset:0
    v_mfma_f32_16x16x32_bf16 v[108:111], v[192:195], v[184:187], v[108:111]
    ds_read_b128 v[40:43], v12 offset:512
    ds_read_b64_tr_b16 v[48:49], v11 offset:0
    ds_read_b64_tr_b16 v[50:51], v11 offset:768
    v_mfma_f32_16x16x32_bf16 v[112:115], v[196:199], v[184:187], v[112:115]
    ds_read_b64_tr_b16 v[52:53], v11 offset:32
    ds_read_b64_tr_b16 v[54:55], v11 offset:800
    ds_read_b128 v[44:47], v12 offset:576
    v_mfma_f32_16x16x32_bf16 v[108:111], v[200:203], v[188:191], v[108:111]
    ds_read_b64_tr_b16 v[56:57], v11 offset:6144
    ds_read_b64_tr_b16 v[58:59], v11 offset:6912
    ds_read_b64_tr_b16 v[60:61], v11 offset:6176
    v_mfma_f32_16x16x32_bf16 v[112:115], v[204:207], v[188:191], v[112:115]
    ds_read_b64_tr_b16 v[62:63], v11 offset:6944
    ds_read_b128 v[64:67], v12 offset:640
    ds_read_b64_tr_b16 v[72:73], v11 offset:22528
    v_mfma_f32_16x16x32_bf16 v[108:111], v[216:219], v[208:211], v[108:111]
    ds_read_b64_tr_b16 v[74:75], v11 offset:23296
    ds_read_b64_tr_b16 v[76:77], v11 offset:22560
    ds_read_b64_tr_b16 v[78:79], v11 offset:23328
    v_mfma_f32_16x16x32_bf16 v[112:115], v[220:223], v[208:211], v[112:115]
    ds_read_b128 v[68:71], v12 offset:704
    ds_read_b64_tr_b16 v[80:81], v11 offset:28672
    ds_read_b64_tr_b16 v[82:83], v11 offset:29440
    v_mfma_f32_16x16x32_bf16 v[108:111], v[224:227], v[212:215], v[108:111]
    ds_read_b64_tr_b16 v[84:85], v11 offset:28704
    ds_read_b64_tr_b16 v[86:87], v11 offset:29472
    v_mfma_f32_16x16x32_bf16 v[112:115], v[228:231], v[212:215], v[112:115]
    s_waitcnt lgkmcnt(0)
    s_barrier
    v_mfma_f32_16x16x32_bf16 v[108:111], v[48:51], v[40:43], v[108:111]
    ds_read_b128 v[184:187], v12 offset:768
    ds_read_b64_tr_b16 v[192:193], v19 offset:0
    ds_read_b64_tr_b16 v[194:195], v19 offset:768
    v_mfma_f32_16x16x32_bf16 v[112:115], v[52:55], v[40:43], v[112:115]
    ds_read_b64_tr_b16 v[196:197], v19 offset:32
    ds_read_b64_tr_b16 v[198:199], v19 offset:800
    ds_read_b128 v[188:191], v12 offset:832
    v_mfma_f32_16x16x32_bf16 v[108:111], v[56:59], v[44:47], v[108:111]
    ds_read_b64_tr_b16 v[200:201], v19 offset:6144
    ds_read_b64_tr_b16 v[202:203], v19 offset:6912
    ds_read_b64_tr_b16 v[204:205], v19 offset:6176
    v_mfma_f32_16x16x32_bf16 v[112:115], v[60:63], v[44:47], v[112:115]
    ds_read_b64_tr_b16 v[206:207], v19 offset:6944
    v_mfma_f32_16x16x32_bf16 v[108:111], v[72:75], v[64:67], v[108:111]
    v_mfma_f32_16x16x32_bf16 v[112:115], v[76:79], v[64:67], v[112:115]
    v_mfma_f32_16x16x32_bf16 v[108:111], v[80:83], v[68:71], v[108:111]
    v_mfma_f32_16x16x32_bf16 v[112:115], v[84:87], v[68:71], v[112:115]
    s_waitcnt lgkmcnt(0)
    s_barrier
    v_mfma_f32_16x16x32_bf16 v[108:111], v[192:195], v[184:187], v[108:111]
    v_mfma_f32_16x16x32_bf16 v[112:115], v[196:199], v[184:187], v[112:115]
    v_mfma_f32_16x16x32_bf16 v[108:111], v[200:203], v[188:191], v[108:111]
    v_mfma_f32_16x16x32_bf16 v[112:115], v[204:207], v[188:191], v[112:115]
    s_waitcnt lgkmcnt(0)
    s_barrier
    s_nop 7
    s_nop 1
    v_and_b32 v6, 15, v1
    v_lshrrev_b32 v7, 4, v1
    s_lshl_b32 s47, s49, 4
    s_add_u32 s47, s47, s46
    v_add_u32 v8, s47, v6
    v_mul_u32_u24 v8, 896, v8
    v_lshlrev_b32 v9, 3, v7
    v_add_u32 v8, v8, v9
    s_lshl_b32 s47, s2, 7
    s_lshl_b32 s48, s50, 6
    s_add_u32 s47, s47, s48
    v_add_u32 v8, s47, v8
    buffer_load_dwordx2 v[20:21], v8, s[16:19], 0 offen offset:0
    buffer_load_dwordx2 v[22:23], v8, s[16:19], 0 offen offset:32
    v_mov_b32 v30, 1.0
    v_mul_f32 v32, 0xbfb8aa3b, v100
    v_mul_f32 v33, 0xbfb8aa3b, v101
    v_mul_f32 v34, 0xbfb8aa3b, v102
    v_mul_f32 v35, 0xbfb8aa3b, v103
    v_exp_f32 v32, v32
    v_exp_f32 v33, v33
    v_exp_f32 v34, v34
    v_exp_f32 v35, v35
    v_add_f32 v32, 1.0, v32
    v_add_f32 v33, 1.0, v33
    v_add_f32 v34, 1.0, v34
    v_add_f32 v35, 1.0, v35
    v_rcp_f32 v32, v32
    v_rcp_f32 v33, v33
    v_rcp_f32 v34, v34
    v_rcp_f32 v35, v35
    v_mul_f32 v32, v32, v100
    v_mul_f32 v33, v33, v101
    v_mul_f32 v34, v34, v102
    v_mul_f32 v35, v35, v103
    v_mul_f32 v100, v32, v30
    v_mul_f32 v101, v33, v30
    v_mul_f32 v102, v34, v30
    v_mul_f32 v103, v35, v30
    v_mul_f32 v32, 0xbfb8aa3b, v104
    v_mul_f32 v33, 0xbfb8aa3b, v105
    v_mul_f32 v34, 0xbfb8aa3b, v106
    v_mul_f32 v35, 0xbfb8aa3b, v107
    v_exp_f32 v32, v32
    v_exp_f32 v33, v33
    v_exp_f32 v34, v34
    v_exp_f32 v35, v35
    v_add_f32 v32, 1.0, v32
    v_add_f32 v33, 1.0, v33
    v_add_f32 v34, 1.0, v34
    v_add_f32 v35, 1.0, v35
    v_rcp_f32 v32, v32
    v_rcp_f32 v33, v33
    v_rcp_f32 v34, v34
    v_rcp_f32 v35, v35
    v_mul_f32 v32, v32, v104
    v_mul_f32 v33, v33, v105
    v_mul_f32 v34, v34, v106
    v_mul_f32 v35, v35, v107
    v_mul_f32 v104, v32, v30
    v_mul_f32 v105, v33, v30
    v_mul_f32 v106, v34, v30
    v_mul_f32 v107, v35, v30
    s_waitcnt vmcnt(0)
    v_lshlrev_b32 v24, 16, v20
    v_and_b32 v25, 0xffff0000, v20
    v_lshlrev_b32 v26, 16, v21
    v_and_b32 v27, 0xffff0000, v21
    v_fmac_f32 v24, v100, v108
    v_fmac_f32 v25, v101, v109
    v_fmac_f32 v26, v102, v110
    v_fmac_f32 v27, v103, v111
    v_cvt_pk_bf16_f32 v24, v24, v25
    v_cvt_pk_bf16_f32 v25, v26, v27
    buffer_store_dwordx2 v[24:25], v8, s[24:27], 0 offen offset:0
    s_nop 1
    v_lshlrev_b32 v24, 16, v22
    v_and_b32 v25, 0xffff0000, v22
    v_lshlrev_b32 v26, 16, v23
    v_and_b32 v27, 0xffff0000, v23
    v_fmac_f32 v24, v104, v112
    v_fmac_f32 v25, v105, v113
    v_fmac_f32 v26, v106, v114
    v_fmac_f32 v27, v107, v115
    v_cvt_pk_bf16_f32 v24, v24, v25
    v_cvt_pk_bf16_f32 v25, v26, v27
    buffer_store_dwordx2 v[24:25], v8, s[24:27], 0 offen offset:32
    s_nop 1
    s_waitcnt vmcnt(0)
k23_done:
    s_endpgm
kr_kernel_body:
    s_and_b32 s60, s2, 1
    s_lshr_b32 s2, s2, 1
    v_cmp_gt_u32 vcc, 256, v0
    s_nop 4
    s_cbranch_vccz kr_done
    s_load_dwordx2 s[4:5], s[0:1], 16
    s_load_dwordx2 s[12:13], s[0:1], 72
    s_waitcnt lgkmcnt(0)
    s_mov_b32 s16, s4
    s_mov_b32 s17, s5
    s_mov_b32 s18, 401408
    s_mov_b32 s19, 0x00020000
    s_mov_b32 s32, s12
    s_mov_b32 s33, s13
    s_mov_b32 s34, 268435456
    s_mov_b32 s35, 0x00020000
    v_lshlrev_b32 v1, 4, v0
    s_lshl_b32 s3, s2, 12
    s_add_u32 s3, s3, 10485760
    buffer_load_dwordx4 v[8:11], v1, s[32:35], s3 offen
    s_add_u32 s3, s3, 0x10000
    buffer_load_dwordx4 v[12:15], v1, s[32:35], s3 offen
    s_add_u32 s3, s3, 0x10000
    buffer_load_dwordx4 v[16:19], v1, s[32:35], s3 offen
    s_add_u32 s3, s3, 0x10000
    buffer_load_dwordx4 v[20:23], v1, s[32:35], s3 offen
    s_add_u32 s3, s3, 0x10000
    buffer_load_dwordx4 v[24:27], v1, s[32:35], s3 offen
    s_add_u32 s3, s3, 0x10000
    buffer_load_dwordx4 v[28:31], v1, s[32:35], s3 offen
    s_add_u32 s3, s3, 0x10000
    buffer_load_dwordx4 v[32:35], v1, s[32:35], s3 offen
    s_add_u32 s3, s3, 0x10000
    buffer_load_dwordx4 v[36:39], v1, s[32:35], s3 offen
    s_add_u32 s3, s3, 0x10000
    buffer_load_dwordx4 v[40:43], v1, s[32:35], s3 offen
    s_add_u32 s3, s3, 0x10000
    buffer_load_dwordx4 v[44:47], v1, s[32:35], s3 offen
    s_add_u32 s3, s3, 0x10000
    buffer_load_dwordx4 v[48:51], v1, s[32:35], s3 offen
    s_add_u32 s3, s3, 0x10000
    buffer_load_dwordx4 v[52:55], v1, s[32:35], s3 offen
    s_add_u32 s3, s3, 0x10000
    buffer_load_dwordx4 v[56:59], v1, s[32:35], s3 offen
    s_add_u32 s3, s3, 0x10000
    buffer_load_dwordx4 v[60:63], v1, s[32:35], s3 offen
    s_add_u32 s3, s3, 0x10000
    buffer_load_dwordx4 v[64:67], v1, s[32:35], s3 offen
    s_add_u32 s3, s3, 0x10000
    buffer_load_dwordx4 v[68:71], v1, s[32:35], s3 offen
    s_add_u32 s3, s3, 0x10000
    v_lshlrev_b32 v2, 2, v0
    s_mul_i32 s3, s2, 25088
    buffer_load_dword v80, v2, s[16:19], s3 offen offset:0
    buffer_load_dword v81, v2, s[16:19], s3 offen offset:896
    buffer_load_dword v82, v2, s[16:19], s3 offen offset:1792
    buffer_load_dword v83, v2, s[16:19], s3 offen offset:2688
    v_add_u32 v3, 3584, v2
    buffer_load_dword v84, v3, s[16:19], s3 offen offset:0
    buffer_load_dword v85, v3, s[16:19], s3 offen offset:896
    buffer_load_dword v86, v3, s[16:19], s3 offen offset:1792
    buffer_load_dword v87, v3, s[16:19], s3 offen offset:2688
    v_add_u32 v3, 7168, v2
    buffer_load_dword v88, v3, s[16:19], s3 offen offset:0
    buffer_load_dword v89, v3, s[16:19], s3 offen offset:896
    buffer_load_dword v90, v3, s[16:19], s3 offen offset:1792
    buffer_load_dword v91, v3, s[16:19], s3 offen offset:2688
    v_add_u32 v3, 10752, v2
    buffer_load_dword v92, v3, s[16:19], s3 offen offset:0
    buffer_load_dword v93, v3, s[16:19], s3 offen offset:896
    buffer_load_dword v94, v3, s[16:19], s3 offen offset:1792
    buffer_load_dword v95, v3, s[16:19], s3 offen offset:2688
    v_add_u32 v3, 14336, v2
    buffer_load_dword v96, v3, s[16:19], s3 offen offset:0
    buffer_load_dword v97, v3, s[16:19], s3 offen offset:896
    buffer_load_dword v98, v3, s[16:19], s3 offen offset:1792
    buffer_load_dword v99, v3, s[16:19], s3 offen offset:2688
    v_add_u32 v3, 17920, v2
    buffer_load_dword v100, v3, s[16:19], s3 offen offset:0
    buffer_load_dword v101, v3, s[16:19], s3 offen offset:896
    buffer_load_dword v102, v3, s[16:19], s3 offen offset:1792
    buffer_load_dword v103, v3, s[16:19], s3 offen offset:2688
    v_add_u32 v3, 21504, v2
    buffer_load_dword v104, v3, s[16:19], s3 offen offset:0
    buffer_load_dword v105, v3, s[16:19], s3 offen offset:896
    buffer_load_dword v106, v3, s[16:19], s3 offen offset:1792
    buffer_load_dword v107, v3, s[16:19], s3 offen offset:2688
    s_waitcnt vmcnt(28)
    v_add_f32 v8, v8, v12
    v_add_f32 v9, v9, v13
    v_add_f32 v10, v10, v14
    v_add_f32 v11, v11, v15
    v_add_f32 v8, v8, v16
    v_add_f32 v9, v9, v17
    v_add_f32 v10, v10, v18
    v_add_f32 v11, v11, v19
    v_add_f32 v8, v8, v20
    v_add_f32 v9, v9, v21
    v_add_f32 v10, v10, v22
    v_add_f32 v11, v11, v23
    v_add_f32 v8, v8, v24
    v_add_f32 v9, v9, v25
    v_add_f32 v10, v10, v26
    v_add_f32 v11, v11, v27
    v_add_f32 v8, v8, v28
    v_add_f32 v9, v9, v29
    v_add_f32 v10, v10, v30
    v_add_f32 v11, v11, v31
    v_add_f32 v8, v8, v32
    v_add_f32 v9, v9, v33
    v_add_f32 v10, v10, v34
    v_add_f32 v11, v11, v35
    v_add_f32 v8, v8, v36
    v_add_f32 v9, v9, v37
    v_add_f32 v10, v10, v38
    v_add_f32 v11, v11, v39
    v_add_f32 v8, v8, v40
    v_add_f32 v9, v9, v41
    v_add_f32 v10, v10, v42
    v_add_f32 v11, v11, v43
    v_add_f32 v8, v8, v44
    v_add_f32 v9, v9, v45
    v_add_f32 v10, v10, v46
    v_add_f32 v11, v11, v47
    v_add_f32 v8, v8, v48
    v_add_f32 v9, v9, v49
    v_add_f32 v10, v10, v50
    v_add_f32 v11, v11, v51
    v_add_f32 v8, v8, v52
    v_add_f32 v9, v9, v53
    v_add_f32 v10, v10, v54
    v_add_f32 v11, v11, v55
    v_add_f32 v8, v8, v56
    v_add_f32 v9, v9, v57
    v_add_f32 v10, v10, v58
    v_add_f32 v11, v11, v59
    v_add_f32 v8, v8, v60
    v_add_f32 v9, v9, v61
    v_add_f32 v10, v10, v62
    v_add_f32 v11, v11, v63
    v_add_f32 v8, v8, v64
    v_add_f32 v9, v9, v65
    v_add_f32 v10, v10, v66
    v_add_f32 v11, v11, v67
    v_add_f32 v8, v8, v68
    v_add_f32 v9, v9, v69
    v_add_f32 v10, v10, v70
    v_add_f32 v11, v11, v71
    v_cvt_pk_bf16_f32 v12, v8, v9
    v_cvt_pk_bf16_f32 v13, v10, v11
    v_lshlrev_b32 v8, 16, v12
    v_and_b32 v9, 0xffff0000, v12
    v_lshlrev_b32 v10, 16, v13
    v_and_b32 v11, 0xffff0000, v13
    ds_write_b128 v1, v[8:11]
    s_waitcnt lgkmcnt(0)
    s_barrier
    v_lshlrev_b32 v4, 7, v0
    ds_read_b32 v5, v4 offset:112
    s_mul_i32 s3, s2, 112
    s_add_u32 s3, s3, 13631488
    v_cmp_gt_u32 vcc, 28, v0
    s_and_saveexec_b64 s[38:39], vcc
    s_cbranch_execz kr_nz
    s_waitcnt lgkmcnt(0)
    buffer_store_dword v5, v2, s[32:35], s3 offen sc1
kr_nz:
    s_mov_b64 exec, s[38:39]
    s_waitcnt vmcnt(0) lgkmcnt(0)
    v_lshlrev_b32 v112, 16, v80
    v_and_b32 v80, 0xffff0000, v80
    v_lshlrev_b32 v113, 16, v81
    v_and_b32 v81, 0xffff0000, v81
    v_lshlrev_b32 v114, 16, v82
    v_and_b32 v82, 0xffff0000, v82
    v_lshlrev_b32 v115, 16, v83
    v_and_b32 v83, 0xffff0000, v83
    v_lshlrev_b32 v116, 16, v84
    v_and_b32 v84, 0xffff0000, v84
    v_lshlrev_b32 v117, 16, v85
    v_and_b32 v85, 0xffff0000, v85
    v_lshlrev_b32 v118, 16, v86
    v_and_b32 v86, 0xffff0000, v86
    v_lshlrev_b32 v119, 16, v87
    v_and_b32 v87, 0xffff0000, v87
    v_lshlrev_b32 v120, 16, v88
    v_and_b32 v88, 0xffff0000, v88
    v_lshlrev_b32 v121, 16, v89
    v_and_b32 v89, 0xffff0000, v89
    v_lshlrev_b32 v122, 16, v90
    v_and_b32 v90, 0xffff0000, v90
    v_lshlrev_b32 v123, 16, v91
    v_and_b32 v91, 0xffff0000, v91
    v_lshlrev_b32 v124, 16, v92
    v_and_b32 v92, 0xffff0000, v92
    v_lshlrev_b32 v125, 16, v93
    v_and_b32 v93, 0xffff0000, v93
    v_lshlrev_b32 v126, 16, v94
    v_and_b32 v94, 0xffff0000, v94
    v_lshlrev_b32 v127, 16, v95
    v_and_b32 v95, 0xffff0000, v95
    v_lshlrev_b32 v128, 16, v96
    v_and_b32 v96, 0xffff0000, v96
    v_lshlrev_b32 v129, 16, v97
    v_and_b32 v97, 0xffff0000, v97
    v_lshlrev_b32 v130, 16, v98
    v_and_b32 v98, 0xffff0000, v98
    v_lshlrev_b32 v131, 16, v99
    v_and_b32 v99, 0xffff0000, v99
    v_lshlrev_b32 v132, 16, v100
    v_and_b32 v100, 0xffff0000, v100
    v_lshlrev_b32 v133, 16, v101
    v_and_b32 v101, 0xffff0000, v101
    v_lshlrev_b32 v134, 16, v102
    v_and_b32 v102, 0xffff0000, v102
    v_lshlrev_b32 v135, 16, v103
    v_and_b32 v103, 0xffff0000, v103
    v_lshlrev_b32 v136, 16, v104
    v_and_b32 v104, 0xffff0000, v104
    v_lshlrev_b32 v137, 16, v105
    v_and_b32 v105, 0xffff0000, v105
    v_lshlrev_b32 v138, 16, v106
    v_and_b32 v106, 0xffff0000, v106
    v_lshlrev_b32 v139, 16, v107
    v_and_b32 v107, 0xffff0000, v107
    s_mul_i32 s61, s60, 1792
    v_mov_b32 v4, s61
    s_mul_i32 s3, s2, 25088
    s_add_u32 s3, s3, 12582912
    s_mul_i32 s61, s60, 12544
    s_add_u32 s3, s3, s61
    v_cmp_gt_u32 vcc, 224, v0
    s_and_saveexec_b64 s[38:39], vcc
    ds_read_b128 v[40:43], v4 offset:0
    ds_read_b128 v[44:47], v4 offset:16
    ds_read_b128 v[48:51], v4 offset:32
    ds_read_b128 v[52:55], v4 offset:48
    ds_read_b128 v[56:59], v4 offset:64
    ds_read_b128 v[60:63], v4 offset:80
    ds_read_b128 v[64:67], v4 offset:96
    s_waitcnt lgkmcnt(0)
    v_mul_f32 v6, v40, v112
    v_mul_f32 v7, v40, v80
    v_fmac_f32 v6, v41, v113
    v_fmac_f32 v7, v41, v81
    v_fmac_f32 v6, v42, v114
    v_fmac_f32 v7, v42, v82
    v_fmac_f32 v6, v43, v115
    v_fmac_f32 v7, v43, v83
    v_fmac_f32 v6, v44, v116
    v_fmac_f32 v7, v44, v84
    v_fmac_f32 v6, v45, v117
    v_fmac_f32 v7, v45, v85
    v_fmac_f32 v6, v46, v118
    v_fmac_f32 v7, v46, v86
    v_fmac_f32 v6, v47, v119
    v_fmac_f32 v7, v47, v87
    v_fmac_f32 v6, v48, v120
    v_fmac_f32 v7, v48, v88
    v_fmac_f32 v6, v49, v121
    v_fmac_f32 v7, v49, v89
    v_fmac_f32 v6, v50, v122
    v_fmac_f32 v7, v50, v90
    v_fmac_f32 v6, v51, v123
    v_fmac_f32 v7, v51, v91
    v_fmac_f32 v6, v52, v124
    v_fmac_f32 v7, v52, v92
    v_fmac_f32 v6, v53, v125
    v_fmac_f32 v7, v53, v93
    v_fmac_f32 v6, v54, v126
    v_fmac_f32 v7, v54, v94
    v_fmac_f32 v6, v55, v127
    v_fmac_f32 v7, v55, v95
    v_fmac_f32 v6, v56, v128
    v_fmac_f32 v7, v56, v96
    v_fmac_f32 v6, v57, v129
    v_fmac_f32 v7, v57, v97
    v_fmac_f32 v6, v58, v130
    v_fmac_f32 v7, v58, v98
    v_fmac_f32 v6, v59, v131
    v_fmac_f32 v7, v59, v99
    v_fmac_f32 v6, v60, v132
    v_fmac_f32 v7, v60, v100
    v_fmac_f32 v6, v61, v133
    v_fmac_f32 v7, v61, v101
    v_fmac_f32 v6, v62, v134
    v_fmac_f32 v7, v62, v102
    v_fmac_f32 v6, v63, v135
    v_fmac_f32 v7, v63, v103
    v_fmac_f32 v6, v64, v136
    v_fmac_f32 v7, v64, v104
    v_fmac_f32 v6, v65, v137
    v_fmac_f32 v7, v65, v105
    v_fmac_f32 v6, v66, v138
    v_fmac_f32 v7, v66, v106
    v_fmac_f32 v6, v67, v139
    v_fmac_f32 v7, v67, v107
    v_cvt_pk_bf16_f32 v6, v6, v7
    buffer_store_dword v6, v2, s[32:35], s3 offen sc1
    s_add_u32 s3, s3, 896
    s_nop 1
    ds_read_b128 v[40:43], v4 offset:128
    ds_read_b128 v[44:47], v4 offset:144
    ds_read_b128 v[48:51], v4 offset:160
    ds_read_b128 v[52:55], v4 offset:176
    ds_read_b128 v[56:59], v4 offset:192
    ds_read_b128 v[60:63], v4 offset:208
    ds_read_b128 v[64:67], v4 offset:224
    s_waitcnt lgkmcnt(0)
    v_mul_f32 v6, v40, v112
    v_mul_f32 v7, v40, v80
    v_fmac_f32 v6, v41, v113
    v_fmac_f32 v7, v41, v81
    v_fmac_f32 v6, v42, v114
    v_fmac_f32 v7, v42, v82
    v_fmac_f32 v6, v43, v115
    v_fmac_f32 v7, v43, v83
    v_fmac_f32 v6, v44, v116
    v_fmac_f32 v7, v44, v84
    v_fmac_f32 v6, v45, v117
    v_fmac_f32 v7, v45, v85
    v_fmac_f32 v6, v46, v118
    v_fmac_f32 v7, v46, v86
    v_fmac_f32 v6, v47, v119
    v_fmac_f32 v7, v47, v87
    v_fmac_f32 v6, v48, v120
    v_fmac_f32 v7, v48, v88
    v_fmac_f32 v6, v49, v121
    v_fmac_f32 v7, v49, v89
    v_fmac_f32 v6, v50, v122
    v_fmac_f32 v7, v50, v90
    v_fmac_f32 v6, v51, v123
    v_fmac_f32 v7, v51, v91
    v_fmac_f32 v6, v52, v124
    v_fmac_f32 v7, v52, v92
    v_fmac_f32 v6, v53, v125
    v_fmac_f32 v7, v53, v93
    v_fmac_f32 v6, v54, v126
    v_fmac_f32 v7, v54, v94
    v_fmac_f32 v6, v55, v127
    v_fmac_f32 v7, v55, v95
    v_fmac_f32 v6, v56, v128
    v_fmac_f32 v7, v56, v96
    v_fmac_f32 v6, v57, v129
    v_fmac_f32 v7, v57, v97
    v_fmac_f32 v6, v58, v130
    v_fmac_f32 v7, v58, v98
    v_fmac_f32 v6, v59, v131
    v_fmac_f32 v7, v59, v99
    v_fmac_f32 v6, v60, v132
    v_fmac_f32 v7, v60, v100
    v_fmac_f32 v6, v61, v133
    v_fmac_f32 v7, v61, v101
    v_fmac_f32 v6, v62, v134
    v_fmac_f32 v7, v62, v102
    v_fmac_f32 v6, v63, v135
    v_fmac_f32 v7, v63, v103
    v_fmac_f32 v6, v64, v136
    v_fmac_f32 v7, v64, v104
    v_fmac_f32 v6, v65, v137
    v_fmac_f32 v7, v65, v105
    v_fmac_f32 v6, v66, v138
    v_fmac_f32 v7, v66, v106
    v_fmac_f32 v6, v67, v139
    v_fmac_f32 v7, v67, v107
    v_cvt_pk_bf16_f32 v6, v6, v7
    buffer_store_dword v6, v2, s[32:35], s3 offen sc1
    s_add_u32 s3, s3, 896
    s_nop 1
    ds_read_b128 v[40:43], v4 offset:256
    ds_read_b128 v[44:47], v4 offset:272
    ds_read_b128 v[48:51], v4 offset:288
    ds_read_b128 v[52:55], v4 offset:304
    ds_read_b128 v[56:59], v4 offset:320
    ds_read_b128 v[60:63], v4 offset:336
    ds_read_b128 v[64:67], v4 offset:352
    s_waitcnt lgkmcnt(0)
    v_mul_f32 v6, v40, v112
    v_mul_f32 v7, v40, v80
    v_fmac_f32 v6, v41, v113
    v_fmac_f32 v7, v41, v81
    v_fmac_f32 v6, v42, v114
    v_fmac_f32 v7, v42, v82
    v_fmac_f32 v6, v43, v115
    v_fmac_f32 v7, v43, v83
    v_fmac_f32 v6, v44, v116
    v_fmac_f32 v7, v44, v84
    v_fmac_f32 v6, v45, v117
    v_fmac_f32 v7, v45, v85
    v_fmac_f32 v6, v46, v118
    v_fmac_f32 v7, v46, v86
    v_fmac_f32 v6, v47, v119
    v_fmac_f32 v7, v47, v87
    v_fmac_f32 v6, v48, v120
    v_fmac_f32 v7, v48, v88
    v_fmac_f32 v6, v49, v121
    v_fmac_f32 v7, v49, v89
    v_fmac_f32 v6, v50, v122
    v_fmac_f32 v7, v50, v90
    v_fmac_f32 v6, v51, v123
    v_fmac_f32 v7, v51, v91
    v_fmac_f32 v6, v52, v124
    v_fmac_f32 v7, v52, v92
    v_fmac_f32 v6, v53, v125
    v_fmac_f32 v7, v53, v93
    v_fmac_f32 v6, v54, v126
    v_fmac_f32 v7, v54, v94
    v_fmac_f32 v6, v55, v127
    v_fmac_f32 v7, v55, v95
    v_fmac_f32 v6, v56, v128
    v_fmac_f32 v7, v56, v96
    v_fmac_f32 v6, v57, v129
    v_fmac_f32 v7, v57, v97
    v_fmac_f32 v6, v58, v130
    v_fmac_f32 v7, v58, v98
    v_fmac_f32 v6, v59, v131
    v_fmac_f32 v7, v59, v99
    v_fmac_f32 v6, v60, v132
    v_fmac_f32 v7, v60, v100
    v_fmac_f32 v6, v61, v133
    v_fmac_f32 v7, v61, v101
    v_fmac_f32 v6, v62, v134
    v_fmac_f32 v7, v62, v102
    v_fmac_f32 v6, v63, v135
    v_fmac_f32 v7, v63, v103
    v_fmac_f32 v6, v64, v136
    v_fmac_f32 v7, v64, v104
    v_fmac_f32 v6, v65, v137
    v_fmac_f32 v7, v65, v105
    v_fmac_f32 v6, v66, v138
    v_fmac_f32 v7, v66, v106
    v_fmac_f32 v6, v67, v139
    v_fmac_f32 v7, v67, v107
    v_cvt_pk_bf16_f32 v6, v6, v7
    buffer_store_dword v6, v2, s[32:35], s3 offen sc1
    s_add_u32 s3, s3, 896
    s_nop 1
    ds_read_b128 v[40:43], v4 offset:384
    ds_read_b128 v[44:47], v4 offset:400
    ds_read_b128 v[48:51], v4 offset:416
    ds_read_b128 v[52:55], v4 offset:432
    ds_read_b128 v[56:59], v4 offset:448
    ds_read_b128 v[60:63], v4 offset:464
    ds_read_b128 v[64:67], v4 offset:480
    s_waitcnt lgkmcnt(0)
    v_mul_f32 v6, v40, v112
    v_mul_f32 v7, v40, v80
    v_fmac_f32 v6, v41, v113
    v_fmac_f32 v7, v41, v81
    v_fmac_f32 v6, v42, v114
    v_fmac_f32 v7, v42, v82
    v_fmac_f32 v6, v43, v115
    v_fmac_f32 v7, v43, v83
    v_fmac_f32 v6, v44, v116
    v_fmac_f32 v7, v44, v84
    v_fmac_f32 v6, v45, v117
    v_fmac_f32 v7, v45, v85
    v_fmac_f32 v6, v46, v118
    v_fmac_f32 v7, v46, v86
    v_fmac_f32 v6, v47, v119
    v_fmac_f32 v7, v47, v87
    v_fmac_f32 v6, v48, v120
    v_fmac_f32 v7, v48, v88
    v_fmac_f32 v6, v49, v121
    v_fmac_f32 v7, v49, v89
    v_fmac_f32 v6, v50, v122
    v_fmac_f32 v7, v50, v90
    v_fmac_f32 v6, v51, v123
    v_fmac_f32 v7, v51, v91
    v_fmac_f32 v6, v52, v124
    v_fmac_f32 v7, v52, v92
    v_fmac_f32 v6, v53, v125
    v_fmac_f32 v7, v53, v93
    v_fmac_f32 v6, v54, v126
    v_fmac_f32 v7, v54, v94
    v_fmac_f32 v6, v55, v127
    v_fmac_f32 v7, v55, v95
    v_fmac_f32 v6, v56, v128
    v_fmac_f32 v7, v56, v96
    v_fmac_f32 v6, v57, v129
    v_fmac_f32 v7, v57, v97
    v_fmac_f32 v6, v58, v130
    v_fmac_f32 v7, v58, v98
    v_fmac_f32 v6, v59, v131
    v_fmac_f32 v7, v59, v99
    v_fmac_f32 v6, v60, v132
    v_fmac_f32 v7, v60, v100
    v_fmac_f32 v6, v61, v133
    v_fmac_f32 v7, v61, v101
    v_fmac_f32 v6, v62, v134
    v_fmac_f32 v7, v62, v102
    v_fmac_f32 v6, v63, v135
    v_fmac_f32 v7, v63, v103
    v_fmac_f32 v6, v64, v136
    v_fmac_f32 v7, v64, v104
    v_fmac_f32 v6, v65, v137
    v_fmac_f32 v7, v65, v105
    v_fmac_f32 v6, v66, v138
    v_fmac_f32 v7, v66, v106
    v_fmac_f32 v6, v67, v139
    v_fmac_f32 v7, v67, v107
    v_cvt_pk_bf16_f32 v6, v6, v7
    buffer_store_dword v6, v2, s[32:35], s3 offen sc1
    s_add_u32 s3, s3, 896
    s_nop 1
    ds_read_b128 v[40:43], v4 offset:512
    ds_read_b128 v[44:47], v4 offset:528
    ds_read_b128 v[48:51], v4 offset:544
    ds_read_b128 v[52:55], v4 offset:560
    ds_read_b128 v[56:59], v4 offset:576
    ds_read_b128 v[60:63], v4 offset:592
    ds_read_b128 v[64:67], v4 offset:608
    s_waitcnt lgkmcnt(0)
    v_mul_f32 v6, v40, v112
    v_mul_f32 v7, v40, v80
    v_fmac_f32 v6, v41, v113
    v_fmac_f32 v7, v41, v81
    v_fmac_f32 v6, v42, v114
    v_fmac_f32 v7, v42, v82
    v_fmac_f32 v6, v43, v115
    v_fmac_f32 v7, v43, v83
    v_fmac_f32 v6, v44, v116
    v_fmac_f32 v7, v44, v84
    v_fmac_f32 v6, v45, v117
    v_fmac_f32 v7, v45, v85
    v_fmac_f32 v6, v46, v118
    v_fmac_f32 v7, v46, v86
    v_fmac_f32 v6, v47, v119
    v_fmac_f32 v7, v47, v87
    v_fmac_f32 v6, v48, v120
    v_fmac_f32 v7, v48, v88
    v_fmac_f32 v6, v49, v121
    v_fmac_f32 v7, v49, v89
    v_fmac_f32 v6, v50, v122
    v_fmac_f32 v7, v50, v90
    v_fmac_f32 v6, v51, v123
    v_fmac_f32 v7, v51, v91
    v_fmac_f32 v6, v52, v124
    v_fmac_f32 v7, v52, v92
    v_fmac_f32 v6, v53, v125
    v_fmac_f32 v7, v53, v93
    v_fmac_f32 v6, v54, v126
    v_fmac_f32 v7, v54, v94
    v_fmac_f32 v6, v55, v127
    v_fmac_f32 v7, v55, v95
    v_fmac_f32 v6, v56, v128
    v_fmac_f32 v7, v56, v96
    v_fmac_f32 v6, v57, v129
    v_fmac_f32 v7, v57, v97
    v_fmac_f32 v6, v58, v130
    v_fmac_f32 v7, v58, v98
    v_fmac_f32 v6, v59, v131
    v_fmac_f32 v7, v59, v99
    v_fmac_f32 v6, v60, v132
    v_fmac_f32 v7, v60, v100
    v_fmac_f32 v6, v61, v133
    v_fmac_f32 v7, v61, v101
    v_fmac_f32 v6, v62, v134
    v_fmac_f32 v7, v62, v102
    v_fmac_f32 v6, v63, v135
    v_fmac_f32 v7, v63, v103
    v_fmac_f32 v6, v64, v136
    v_fmac_f32 v7, v64, v104
    v_fmac_f32 v6, v65, v137
    v_fmac_f32 v7, v65, v105
    v_fmac_f32 v6, v66, v138
    v_fmac_f32 v7, v66, v106
    v_fmac_f32 v6, v67, v139
    v_fmac_f32 v7, v67, v107
    v_cvt_pk_bf16_f32 v6, v6, v7
    buffer_store_dword v6, v2, s[32:35], s3 offen sc1
    s_add_u32 s3, s3, 896
    s_nop 1
    ds_read_b128 v[40:43], v4 offset:640
    ds_read_b128 v[44:47], v4 offset:656
    ds_read_b128 v[48:51], v4 offset:672
    ds_read_b128 v[52:55], v4 offset:688
    ds_read_b128 v[56:59], v4 offset:704
    ds_read_b128 v[60:63], v4 offset:720
    ds_read_b128 v[64:67], v4 offset:736
    s_waitcnt lgkmcnt(0)
    v_mul_f32 v6, v40, v112
    v_mul_f32 v7, v40, v80
    v_fmac_f32 v6, v41, v113
    v_fmac_f32 v7, v41, v81
    v_fmac_f32 v6, v42, v114
    v_fmac_f32 v7, v42, v82
    v_fmac_f32 v6, v43, v115
    v_fmac_f32 v7, v43, v83
    v_fmac_f32 v6, v44, v116
    v_fmac_f32 v7, v44, v84
    v_fmac_f32 v6, v45, v117
    v_fmac_f32 v7, v45, v85
    v_fmac_f32 v6, v46, v118
    v_fmac_f32 v7, v46, v86
    v_fmac_f32 v6, v47, v119
    v_fmac_f32 v7, v47, v87
    v_fmac_f32 v6, v48, v120
    v_fmac_f32 v7, v48, v88
    v_fmac_f32 v6, v49, v121
    v_fmac_f32 v7, v49, v89
    v_fmac_f32 v6, v50, v122
    v_fmac_f32 v7, v50, v90
    v_fmac_f32 v6, v51, v123
    v_fmac_f32 v7, v51, v91
    v_fmac_f32 v6, v52, v124
    v_fmac_f32 v7, v52, v92
    v_fmac_f32 v6, v53, v125
    v_fmac_f32 v7, v53, v93
    v_fmac_f32 v6, v54, v126
    v_fmac_f32 v7, v54, v94
    v_fmac_f32 v6, v55, v127
    v_fmac_f32 v7, v55, v95
    v_fmac_f32 v6, v56, v128
    v_fmac_f32 v7, v56, v96
    v_fmac_f32 v6, v57, v129
    v_fmac_f32 v7, v57, v97
    v_fmac_f32 v6, v58, v130
    v_fmac_f32 v7, v58, v98
    v_fmac_f32 v6, v59, v131
    v_fmac_f32 v7, v59, v99
    v_fmac_f32 v6, v60, v132
    v_fmac_f32 v7, v60, v100
    v_fmac_f32 v6, v61, v133
    v_fmac_f32 v7, v61, v101
    v_fmac_f32 v6, v62, v134
    v_fmac_f32 v7, v62, v102
    v_fmac_f32 v6, v63, v135
    v_fmac_f32 v7, v63, v103
    v_fmac_f32 v6, v64, v136
    v_fmac_f32 v7, v64, v104
    v_fmac_f32 v6, v65, v137
    v_fmac_f32 v7, v65, v105
    v_fmac_f32 v6, v66, v138
    v_fmac_f32 v7, v66, v106
    v_fmac_f32 v6, v67, v139
    v_fmac_f32 v7, v67, v107
    v_cvt_pk_bf16_f32 v6, v6, v7
    buffer_store_dword v6, v2, s[32:35], s3 offen sc1
    s_add_u32 s3, s3, 896
    s_nop 1
    ds_read_b128 v[40:43], v4 offset:768
    ds_read_b128 v[44:47], v4 offset:784
    ds_read_b128 v[48:51], v4 offset:800
    ds_read_b128 v[52:55], v4 offset:816
    ds_read_b128 v[56:59], v4 offset:832
    ds_read_b128 v[60:63], v4 offset:848
    ds_read_b128 v[64:67], v4 offset:864
    s_waitcnt lgkmcnt(0)
    v_mul_f32 v6, v40, v112
    v_mul_f32 v7, v40, v80
    v_fmac_f32 v6, v41, v113
    v_fmac_f32 v7, v41, v81
    v_fmac_f32 v6, v42, v114
    v_fmac_f32 v7, v42, v82
    v_fmac_f32 v6, v43, v115
    v_fmac_f32 v7, v43, v83
    v_fmac_f32 v6, v44, v116
    v_fmac_f32 v7, v44, v84
    v_fmac_f32 v6, v45, v117
    v_fmac_f32 v7, v45, v85
    v_fmac_f32 v6, v46, v118
    v_fmac_f32 v7, v46, v86
    v_fmac_f32 v6, v47, v119
    v_fmac_f32 v7, v47, v87
    v_fmac_f32 v6, v48, v120
    v_fmac_f32 v7, v48, v88
    v_fmac_f32 v6, v49, v121
    v_fmac_f32 v7, v49, v89
    v_fmac_f32 v6, v50, v122
    v_fmac_f32 v7, v50, v90
    v_fmac_f32 v6, v51, v123
    v_fmac_f32 v7, v51, v91
    v_fmac_f32 v6, v52, v124
    v_fmac_f32 v7, v52, v92
    v_fmac_f32 v6, v53, v125
    v_fmac_f32 v7, v53, v93
    v_fmac_f32 v6, v54, v126
    v_fmac_f32 v7, v54, v94
    v_fmac_f32 v6, v55, v127
    v_fmac_f32 v7, v55, v95
    v_fmac_f32 v6, v56, v128
    v_fmac_f32 v7, v56, v96
    v_fmac_f32 v6, v57, v129
    v_fmac_f32 v7, v57, v97
    v_fmac_f32 v6, v58, v130
    v_fmac_f32 v7, v58, v98
    v_fmac_f32 v6, v59, v131
    v_fmac_f32 v7, v59, v99
    v_fmac_f32 v6, v60, v132
    v_fmac_f32 v7, v60, v100
    v_fmac_f32 v6, v61, v133
    v_fmac_f32 v7, v61, v101
    v_fmac_f32 v6, v62, v134
    v_fmac_f32 v7, v62, v102
    v_fmac_f32 v6, v63, v135
    v_fmac_f32 v7, v63, v103
    v_fmac_f32 v6, v64, v136
    v_fmac_f32 v7, v64, v104
    v_fmac_f32 v6, v65, v137
    v_fmac_f32 v7, v65, v105
    v_fmac_f32 v6, v66, v138
    v_fmac_f32 v7, v66, v106
    v_fmac_f32 v6, v67, v139
    v_fmac_f32 v7, v67, v107
    v_cvt_pk_bf16_f32 v6, v6, v7
    buffer_store_dword v6, v2, s[32:35], s3 offen sc1
    s_add_u32 s3, s3, 896
    s_nop 1
    ds_read_b128 v[40:43], v4 offset:896
    ds_read_b128 v[44:47], v4 offset:912
    ds_read_b128 v[48:51], v4 offset:928
    ds_read_b128 v[52:55], v4 offset:944
    ds_read_b128 v[56:59], v4 offset:960
    ds_read_b128 v[60:63], v4 offset:976
    ds_read_b128 v[64:67], v4 offset:992
    s_waitcnt lgkmcnt(0)
    v_mul_f32 v6, v40, v112
    v_mul_f32 v7, v40, v80
    v_fmac_f32 v6, v41, v113
    v_fmac_f32 v7, v41, v81
    v_fmac_f32 v6, v42, v114
    v_fmac_f32 v7, v42, v82
    v_fmac_f32 v6, v43, v115
    v_fmac_f32 v7, v43, v83
    v_fmac_f32 v6, v44, v116
    v_fmac_f32 v7, v44, v84
    v_fmac_f32 v6, v45, v117
    v_fmac_f32 v7, v45, v85
    v_fmac_f32 v6, v46, v118
    v_fmac_f32 v7, v46, v86
    v_fmac_f32 v6, v47, v119
    v_fmac_f32 v7, v47, v87
    v_fmac_f32 v6, v48, v120
    v_fmac_f32 v7, v48, v88
    v_fmac_f32 v6, v49, v121
    v_fmac_f32 v7, v49, v89
    v_fmac_f32 v6, v50, v122
    v_fmac_f32 v7, v50, v90
    v_fmac_f32 v6, v51, v123
    v_fmac_f32 v7, v51, v91
    v_fmac_f32 v6, v52, v124
    v_fmac_f32 v7, v52, v92
    v_fmac_f32 v6, v53, v125
    v_fmac_f32 v7, v53, v93
    v_fmac_f32 v6, v54, v126
    v_fmac_f32 v7, v54, v94
    v_fmac_f32 v6, v55, v127
    v_fmac_f32 v7, v55, v95
    v_fmac_f32 v6, v56, v128
    v_fmac_f32 v7, v56, v96
    v_fmac_f32 v6, v57, v129
    v_fmac_f32 v7, v57, v97
    v_fmac_f32 v6, v58, v130
    v_fmac_f32 v7, v58, v98
    v_fmac_f32 v6, v59, v131
    v_fmac_f32 v7, v59, v99
    v_fmac_f32 v6, v60, v132
    v_fmac_f32 v7, v60, v100
    v_fmac_f32 v6, v61, v133
    v_fmac_f32 v7, v61, v101
    v_fmac_f32 v6, v62, v134
    v_fmac_f32 v7, v62, v102
    v_fmac_f32 v6, v63, v135
    v_fmac_f32 v7, v63, v103
    v_fmac_f32 v6, v64, v136
    v_fmac_f32 v7, v64, v104
    v_fmac_f32 v6, v65, v137
    v_fmac_f32 v7, v65, v105
    v_fmac_f32 v6, v66, v138
    v_fmac_f32 v7, v66, v106
    v_fmac_f32 v6, v67, v139
    v_fmac_f32 v7, v67, v107
    v_cvt_pk_bf16_f32 v6, v6, v7
    buffer_store_dword v6, v2, s[32:35], s3 offen sc1
    s_add_u32 s3, s3, 896
    s_nop 1
    ds_read_b128 v[40:43], v4 offset:1024
    ds_read_b128 v[44:47], v4 offset:1040
    ds_read_b128 v[48:51], v4 offset:1056
    ds_read_b128 v[52:55], v4 offset:1072
    ds_read_b128 v[56:59], v4 offset:1088
    ds_read_b128 v[60:63], v4 offset:1104
    ds_read_b128 v[64:67], v4 offset:1120
    s_waitcnt lgkmcnt(0)
    v_mul_f32 v6, v40, v112
    v_mul_f32 v7, v40, v80
    v_fmac_f32 v6, v41, v113
    v_fmac_f32 v7, v41, v81
    v_fmac_f32 v6, v42, v114
    v_fmac_f32 v7, v42, v82
    v_fmac_f32 v6, v43, v115
    v_fmac_f32 v7, v43, v83
    v_fmac_f32 v6, v44, v116
    v_fmac_f32 v7, v44, v84
    v_fmac_f32 v6, v45, v117
    v_fmac_f32 v7, v45, v85
    v_fmac_f32 v6, v46, v118
    v_fmac_f32 v7, v46, v86
    v_fmac_f32 v6, v47, v119
    v_fmac_f32 v7, v47, v87
    v_fmac_f32 v6, v48, v120
    v_fmac_f32 v7, v48, v88
    v_fmac_f32 v6, v49, v121
    v_fmac_f32 v7, v49, v89
    v_fmac_f32 v6, v50, v122
    v_fmac_f32 v7, v50, v90
    v_fmac_f32 v6, v51, v123
    v_fmac_f32 v7, v51, v91
    v_fmac_f32 v6, v52, v124
    v_fmac_f32 v7, v52, v92
    v_fmac_f32 v6, v53, v125
    v_fmac_f32 v7, v53, v93
    v_fmac_f32 v6, v54, v126
    v_fmac_f32 v7, v54, v94
    v_fmac_f32 v6, v55, v127
    v_fmac_f32 v7, v55, v95
    v_fmac_f32 v6, v56, v128
    v_fmac_f32 v7, v56, v96
    v_fmac_f32 v6, v57, v129
    v_fmac_f32 v7, v57, v97
    v_fmac_f32 v6, v58, v130
    v_fmac_f32 v7, v58, v98
    v_fmac_f32 v6, v59, v131
    v_fmac_f32 v7, v59, v99
    v_fmac_f32 v6, v60, v132
    v_fmac_f32 v7, v60, v100
    v_fmac_f32 v6, v61, v133
    v_fmac_f32 v7, v61, v101
    v_fmac_f32 v6, v62, v134
    v_fmac_f32 v7, v62, v102
    v_fmac_f32 v6, v63, v135
    v_fmac_f32 v7, v63, v103
    v_fmac_f32 v6, v64, v136
    v_fmac_f32 v7, v64, v104
    v_fmac_f32 v6, v65, v137
    v_fmac_f32 v7, v65, v105
    v_fmac_f32 v6, v66, v138
    v_fmac_f32 v7, v66, v106
    v_fmac_f32 v6, v67, v139
    v_fmac_f32 v7, v67, v107
    v_cvt_pk_bf16_f32 v6, v6, v7
    buffer_store_dword v6, v2, s[32:35], s3 offen sc1
    s_add_u32 s3, s3, 896
    s_nop 1
    ds_read_b128 v[40:43], v4 offset:1152
    ds_read_b128 v[44:47], v4 offset:1168
    ds_read_b128 v[48:51], v4 offset:1184
    ds_read_b128 v[52:55], v4 offset:1200
    ds_read_b128 v[56:59], v4 offset:1216
    ds_read_b128 v[60:63], v4 offset:1232
    ds_read_b128 v[64:67], v4 offset:1248
    s_waitcnt lgkmcnt(0)
    v_mul_f32 v6, v40, v112
    v_mul_f32 v7, v40, v80
    v_fmac_f32 v6, v41, v113
    v_fmac_f32 v7, v41, v81
    v_fmac_f32 v6, v42, v114
    v_fmac_f32 v7, v42, v82
    v_fmac_f32 v6, v43, v115
    v_fmac_f32 v7, v43, v83
    v_fmac_f32 v6, v44, v116
    v_fmac_f32 v7, v44, v84
    v_fmac_f32 v6, v45, v117
    v_fmac_f32 v7, v45, v85
    v_fmac_f32 v6, v46, v118
    v_fmac_f32 v7, v46, v86
    v_fmac_f32 v6, v47, v119
    v_fmac_f32 v7, v47, v87
    v_fmac_f32 v6, v48, v120
    v_fmac_f32 v7, v48, v88
    v_fmac_f32 v6, v49, v121
    v_fmac_f32 v7, v49, v89
    v_fmac_f32 v6, v50, v122
    v_fmac_f32 v7, v50, v90
    v_fmac_f32 v6, v51, v123
    v_fmac_f32 v7, v51, v91
    v_fmac_f32 v6, v52, v124
    v_fmac_f32 v7, v52, v92
    v_fmac_f32 v6, v53, v125
    v_fmac_f32 v7, v53, v93
    v_fmac_f32 v6, v54, v126
    v_fmac_f32 v7, v54, v94
    v_fmac_f32 v6, v55, v127
    v_fmac_f32 v7, v55, v95
    v_fmac_f32 v6, v56, v128
    v_fmac_f32 v7, v56, v96
    v_fmac_f32 v6, v57, v129
    v_fmac_f32 v7, v57, v97
    v_fmac_f32 v6, v58, v130
    v_fmac_f32 v7, v58, v98
    v_fmac_f32 v6, v59, v131
    v_fmac_f32 v7, v59, v99
    v_fmac_f32 v6, v60, v132
    v_fmac_f32 v7, v60, v100
    v_fmac_f32 v6, v61, v133
    v_fmac_f32 v7, v61, v101
    v_fmac_f32 v6, v62, v134
    v_fmac_f32 v7, v62, v102
    v_fmac_f32 v6, v63, v135
    v_fmac_f32 v7, v63, v103
    v_fmac_f32 v6, v64, v136
    v_fmac_f32 v7, v64, v104
    v_fmac_f32 v6, v65, v137
    v_fmac_f32 v7, v65, v105
    v_fmac_f32 v6, v66, v138
    v_fmac_f32 v7, v66, v106
    v_fmac_f32 v6, v67, v139
    v_fmac_f32 v7, v67, v107
    v_cvt_pk_bf16_f32 v6, v6, v7
    buffer_store_dword v6, v2, s[32:35], s3 offen sc1
    s_add_u32 s3, s3, 896
    s_nop 1
    ds_read_b128 v[40:43], v4 offset:1280
    ds_read_b128 v[44:47], v4 offset:1296
    ds_read_b128 v[48:51], v4 offset:1312
    ds_read_b128 v[52:55], v4 offset:1328
    ds_read_b128 v[56:59], v4 offset:1344
    ds_read_b128 v[60:63], v4 offset:1360
    ds_read_b128 v[64:67], v4 offset:1376
    s_waitcnt lgkmcnt(0)
    v_mul_f32 v6, v40, v112
    v_mul_f32 v7, v40, v80
    v_fmac_f32 v6, v41, v113
    v_fmac_f32 v7, v41, v81
    v_fmac_f32 v6, v42, v114
    v_fmac_f32 v7, v42, v82
    v_fmac_f32 v6, v43, v115
    v_fmac_f32 v7, v43, v83
    v_fmac_f32 v6, v44, v116
    v_fmac_f32 v7, v44, v84
    v_fmac_f32 v6, v45, v117
    v_fmac_f32 v7, v45, v85
    v_fmac_f32 v6, v46, v118
    v_fmac_f32 v7, v46, v86
    v_fmac_f32 v6, v47, v119
    v_fmac_f32 v7, v47, v87
    v_fmac_f32 v6, v48, v120
    v_fmac_f32 v7, v48, v88
    v_fmac_f32 v6, v49, v121
    v_fmac_f32 v7, v49, v89
    v_fmac_f32 v6, v50, v122
    v_fmac_f32 v7, v50, v90
    v_fmac_f32 v6, v51, v123
    v_fmac_f32 v7, v51, v91
    v_fmac_f32 v6, v52, v124
    v_fmac_f32 v7, v52, v92
    v_fmac_f32 v6, v53, v125
    v_fmac_f32 v7, v53, v93
    v_fmac_f32 v6, v54, v126
    v_fmac_f32 v7, v54, v94
    v_fmac_f32 v6, v55, v127
    v_fmac_f32 v7, v55, v95
    v_fmac_f32 v6, v56, v128
    v_fmac_f32 v7, v56, v96
    v_fmac_f32 v6, v57, v129
    v_fmac_f32 v7, v57, v97
    v_fmac_f32 v6, v58, v130
    v_fmac_f32 v7, v58, v98
    v_fmac_f32 v6, v59, v131
    v_fmac_f32 v7, v59, v99
    v_fmac_f32 v6, v60, v132
    v_fmac_f32 v7, v60, v100
    v_fmac_f32 v6, v61, v133
    v_fmac_f32 v7, v61, v101
    v_fmac_f32 v6, v62, v134
    v_fmac_f32 v7, v62, v102
    v_fmac_f32 v6, v63, v135
    v_fmac_f32 v7, v63, v103
    v_fmac_f32 v6, v64, v136
    v_fmac_f32 v7, v64, v104
    v_fmac_f32 v6, v65, v137
    v_fmac_f32 v7, v65, v105
    v_fmac_f32 v6, v66, v138
    v_fmac_f32 v7, v66, v106
    v_fmac_f32 v6, v67, v139
    v_fmac_f32 v7, v67, v107
    v_cvt_pk_bf16_f32 v6, v6, v7
    buffer_store_dword v6, v2, s[32:35], s3 offen sc1
    s_add_u32 s3, s3, 896
    s_nop 1
    ds_read_b128 v[40:43], v4 offset:1408
    ds_read_b128 v[44:47], v4 offset:1424
    ds_read_b128 v[48:51], v4 offset:1440
    ds_read_b128 v[52:55], v4 offset:1456
    ds_read_b128 v[56:59], v4 offset:1472
    ds_read_b128 v[60:63], v4 offset:1488
    ds_read_b128 v[64:67], v4 offset:1504
    s_waitcnt lgkmcnt(0)
    v_mul_f32 v6, v40, v112
    v_mul_f32 v7, v40, v80
    v_fmac_f32 v6, v41, v113
    v_fmac_f32 v7, v41, v81
    v_fmac_f32 v6, v42, v114
    v_fmac_f32 v7, v42, v82
    v_fmac_f32 v6, v43, v115
    v_fmac_f32 v7, v43, v83
    v_fmac_f32 v6, v44, v116
    v_fmac_f32 v7, v44, v84
    v_fmac_f32 v6, v45, v117
    v_fmac_f32 v7, v45, v85
    v_fmac_f32 v6, v46, v118
    v_fmac_f32 v7, v46, v86
    v_fmac_f32 v6, v47, v119
    v_fmac_f32 v7, v47, v87
    v_fmac_f32 v6, v48, v120
    v_fmac_f32 v7, v48, v88
    v_fmac_f32 v6, v49, v121
    v_fmac_f32 v7, v49, v89
    v_fmac_f32 v6, v50, v122
    v_fmac_f32 v7, v50, v90
    v_fmac_f32 v6, v51, v123
    v_fmac_f32 v7, v51, v91
    v_fmac_f32 v6, v52, v124
    v_fmac_f32 v7, v52, v92
    v_fmac_f32 v6, v53, v125
    v_fmac_f32 v7, v53, v93
    v_fmac_f32 v6, v54, v126
    v_fmac_f32 v7, v54, v94
    v_fmac_f32 v6, v55, v127
    v_fmac_f32 v7, v55, v95
    v_fmac_f32 v6, v56, v128
    v_fmac_f32 v7, v56, v96
    v_fmac_f32 v6, v57, v129
    v_fmac_f32 v7, v57, v97
    v_fmac_f32 v6, v58, v130
    v_fmac_f32 v7, v58, v98
    v_fmac_f32 v6, v59, v131
    v_fmac_f32 v7, v59, v99
    v_fmac_f32 v6, v60, v132
    v_fmac_f32 v7, v60, v100
    v_fmac_f32 v6, v61, v133
    v_fmac_f32 v7, v61, v101
    v_fmac_f32 v6, v62, v134
    v_fmac_f32 v7, v62, v102
    v_fmac_f32 v6, v63, v135
    v_fmac_f32 v7, v63, v103
    v_fmac_f32 v6, v64, v136
    v_fmac_f32 v7, v64, v104
    v_fmac_f32 v6, v65, v137
    v_fmac_f32 v7, v65, v105
    v_fmac_f32 v6, v66, v138
    v_fmac_f32 v7, v66, v106
    v_fmac_f32 v6, v67, v139
    v_fmac_f32 v7, v67, v107
    v_cvt_pk_bf16_f32 v6, v6, v7
    buffer_store_dword v6, v2, s[32:35], s3 offen sc1
    s_add_u32 s3, s3, 896
    s_nop 1
    ds_read_b128 v[40:43], v4 offset:1536
    ds_read_b128 v[44:47], v4 offset:1552
    ds_read_b128 v[48:51], v4 offset:1568
    ds_read_b128 v[52:55], v4 offset:1584
    ds_read_b128 v[56:59], v4 offset:1600
    ds_read_b128 v[60:63], v4 offset:1616
    ds_read_b128 v[64:67], v4 offset:1632
    s_waitcnt lgkmcnt(0)
    v_mul_f32 v6, v40, v112
    v_mul_f32 v7, v40, v80
    v_fmac_f32 v6, v41, v113
    v_fmac_f32 v7, v41, v81
    v_fmac_f32 v6, v42, v114
    v_fmac_f32 v7, v42, v82
    v_fmac_f32 v6, v43, v115
    v_fmac_f32 v7, v43, v83
    v_fmac_f32 v6, v44, v116
    v_fmac_f32 v7, v44, v84
    v_fmac_f32 v6, v45, v117
    v_fmac_f32 v7, v45, v85
    v_fmac_f32 v6, v46, v118
    v_fmac_f32 v7, v46, v86
    v_fmac_f32 v6, v47, v119
    v_fmac_f32 v7, v47, v87
    v_fmac_f32 v6, v48, v120
    v_fmac_f32 v7, v48, v88
    v_fmac_f32 v6, v49, v121
    v_fmac_f32 v7, v49, v89
    v_fmac_f32 v6, v50, v122
    v_fmac_f32 v7, v50, v90
    v_fmac_f32 v6, v51, v123
    v_fmac_f32 v7, v51, v91
    v_fmac_f32 v6, v52, v124
    v_fmac_f32 v7, v52, v92
    v_fmac_f32 v6, v53, v125
    v_fmac_f32 v7, v53, v93
    v_fmac_f32 v6, v54, v126
    v_fmac_f32 v7, v54, v94
    v_fmac_f32 v6, v55, v127
    v_fmac_f32 v7, v55, v95
    v_fmac_f32 v6, v56, v128
    v_fmac_f32 v7, v56, v96
    v_fmac_f32 v6, v57, v129
    v_fmac_f32 v7, v57, v97
    v_fmac_f32 v6, v58, v130
    v_fmac_f32 v7, v58, v98
    v_fmac_f32 v6, v59, v131
    v_fmac_f32 v7, v59, v99
    v_fmac_f32 v6, v60, v132
    v_fmac_f32 v7, v60, v100
    v_fmac_f32 v6, v61, v133
    v_fmac_f32 v7, v61, v101
    v_fmac_f32 v6, v62, v134
    v_fmac_f32 v7, v62, v102
    v_fmac_f32 v6, v63, v135
    v_fmac_f32 v7, v63, v103
    v_fmac_f32 v6, v64, v136
    v_fmac_f32 v7, v64, v104
    v_fmac_f32 v6, v65, v137
    v_fmac_f32 v7, v65, v105
    v_fmac_f32 v6, v66, v138
    v_fmac_f32 v7, v66, v106
    v_fmac_f32 v6, v67, v139
    v_fmac_f32 v7, v67, v107
    v_cvt_pk_bf16_f32 v6, v6, v7
    buffer_store_dword v6, v2, s[32:35], s3 offen sc1
    s_add_u32 s3, s3, 896
    s_nop 1
    ds_read_b128 v[40:43], v4 offset:1664
    ds_read_b128 v[44:47], v4 offset:1680
    ds_read_b128 v[48:51], v4 offset:1696
    ds_read_b128 v[52:55], v4 offset:1712
    ds_read_b128 v[56:59], v4 offset:1728
    ds_read_b128 v[60:63], v4 offset:1744
    ds_read_b128 v[64:67], v4 offset:1760
    s_waitcnt lgkmcnt(0)
    v_mul_f32 v6, v40, v112
    v_mul_f32 v7, v40, v80
    v_fmac_f32 v6, v41, v113
    v_fmac_f32 v7, v41, v81
    v_fmac_f32 v6, v42, v114
    v_fmac_f32 v7, v42, v82
    v_fmac_f32 v6, v43, v115
    v_fmac_f32 v7, v43, v83
    v_fmac_f32 v6, v44, v116
    v_fmac_f32 v7, v44, v84
    v_fmac_f32 v6, v45, v117
    v_fmac_f32 v7, v45, v85
    v_fmac_f32 v6, v46, v118
    v_fmac_f32 v7, v46, v86
    v_fmac_f32 v6, v47, v119
    v_fmac_f32 v7, v47, v87
    v_fmac_f32 v6, v48, v120
    v_fmac_f32 v7, v48, v88
    v_fmac_f32 v6, v49, v121
    v_fmac_f32 v7, v49, v89
    v_fmac_f32 v6, v50, v122
    v_fmac_f32 v7, v50, v90
    v_fmac_f32 v6, v51, v123
    v_fmac_f32 v7, v51, v91
    v_fmac_f32 v6, v52, v124
    v_fmac_f32 v7, v52, v92
    v_fmac_f32 v6, v53, v125
    v_fmac_f32 v7, v53, v93
    v_fmac_f32 v6, v54, v126
    v_fmac_f32 v7, v54, v94
    v_fmac_f32 v6, v55, v127
    v_fmac_f32 v7, v55, v95
    v_fmac_f32 v6, v56, v128
    v_fmac_f32 v7, v56, v96
    v_fmac_f32 v6, v57, v129
    v_fmac_f32 v7, v57, v97
    v_fmac_f32 v6, v58, v130
    v_fmac_f32 v7, v58, v98
    v_fmac_f32 v6, v59, v131
    v_fmac_f32 v7, v59, v99
    v_fmac_f32 v6, v60, v132
    v_fmac_f32 v7, v60, v100
    v_fmac_f32 v6, v61, v133
    v_fmac_f32 v7, v61, v101
    v_fmac_f32 v6, v62, v134
    v_fmac_f32 v7, v62, v102
    v_fmac_f32 v6, v63, v135
    v_fmac_f32 v7, v63, v103
    v_fmac_f32 v6, v64, v136
    v_fmac_f32 v7, v64, v104
    v_fmac_f32 v6, v65, v137
    v_fmac_f32 v7, v65, v105
    v_fmac_f32 v6, v66, v138
    v_fmac_f32 v7, v66, v106
    v_fmac_f32 v6, v67, v139
    v_fmac_f32 v7, v67, v107
    v_cvt_pk_bf16_f32 v6, v6, v7
    buffer_store_dword v6, v2, s[32:35], s3 offen sc1
    s_add_u32 s3, s3, 896
    s_nop 1
    s_mov_b64 exec, -1
    s_waitcnt vmcnt(0)
    s_barrier
    s_load_dwordx2 s[56:57], s[0:1], 64
    s_waitcnt lgkmcnt(0)
    s_mov_b32 s58, 256
    s_mov_b32 s59, 0x00020000
    v_mov_b32 v5, 1
    v_mov_b32 v4, 0
    v_cmp_eq_u32 vcc, 0, v0
    s_and_saveexec_b64 s[38:39], vcc
    s_cbranch_execz kr_done
    buffer_atomic_add v5, v4, s[56:59], 0 offen sc1
    s_waitcnt vmcnt(0)
kr_done:
    s_endpgm
.section .rodata,"a"
.p2align 6
.amdhsa_kernel k1_kernel
  .amdhsa_next_free_vgpr 240
  .amdhsa_next_free_sgpr 102
  .amdhsa_accum_offset 240
  .amdhsa_group_segment_fixed_size 0
  .amdhsa_kernarg_size 80
  .amdhsa_user_sgpr_count 2
  .amdhsa_user_sgpr_kernarg_segment_ptr 1
  .amdhsa_system_sgpr_workgroup_id_x 1
.end_amdhsa_kernel
.p2align 6
.amdhsa_kernel k23_kernel
  .amdhsa_next_free_vgpr 256
  .amdhsa_next_free_sgpr 102
  .amdhsa_accum_offset 256
  .amdhsa_group_segment_fixed_size 0
  .amdhsa_kernarg_size 80
  .amdhsa_user_sgpr_count 2
  .amdhsa_user_sgpr_kernarg_segment_ptr 1
  .amdhsa_system_sgpr_workgroup_id_x 1
.end_amdhsa_kernel
```
